```python
import torch

def _softmax(x, axis=-1):
    return torch.softmax(x, dim=axis)
def _gelu(x):
    return torch.nn.functional.gelu(x, approximate="tanh")
def _silu(x):
    return torch.nn.functional.silu(x)
def _sigmoid(x):
    return torch.sigmoid(x)
def _layernorm(x, axis=-1, eps=1e-5):
    m = x.mean(dim=axis, keepdim=True)
    v = x.var(dim=axis, keepdim=True, unbiased=False)
    return (x - m) / torch.sqrt(v + eps)
def _scatter_add(tgt, idx, src, axis=0):
    return tgt.clone().index_add_(axis, idx, src)
def _segment_sum(src, seg, n):
    out = torch.zeros((n,) + src.shape[1:], dtype=src.dtype)
    return out.index_add_(0, seg, src)
def _pad(x, pw):
    flat = tuple(v for pair in reversed(pw) for v in pair)
    return torch.nn.functional.pad(x, flat)

kernel_name = 'sequential_preLN__gqa_block_cached__mixer_token_mlp__decode'

def setup_inputs():

    _w = (lambda a: (lambda t: t.to(torch.bfloat16) if t.is_floating_point() else t)(torch.as_tensor(a)))
    def _A_setup():
        B, Sq, D = 2, 1, 640
        Hq, Hkv, Sk, Dh = 32, 32, 8192, 192
        assert Hq % Hkv == 0, (Hq, Hkv)
        return {
            "x": _w((lambda *s: torch.randn(*s, dtype=torch.bfloat16) * 0.05)(B, Sq, D)),
            "k_cache": _w((lambda *s: torch.randn(*s, dtype=torch.bfloat16) * 1.6)(B, Hkv, Sk, Dh)),
            "v_cache": _w((lambda *s: torch.randn(*s, dtype=torch.bfloat16) * 0.8)(B, Hkv, Sk, Dh)),
            "wq": _w((lambda *s: torch.randn(*s, dtype=torch.bfloat16) * 1.6)(D, Hq * Dh) * (D ** -0.5)),
            "wo": _w((lambda *s: torch.randn(*s, dtype=torch.bfloat16) * 0.8)(Hq * Dh, D) * ((Hq * Dh) ** -0.5)),
        }
    _A_in = _A_setup()

    def _B_setup():
        B, S, D, F = 2, 1, 640, 1536
        return {
            "x": _w((lambda *s: torch.randn(*s, dtype=torch.bfloat16) * 0.05)(B, S, D)),
            "w1": _w((lambda *s: torch.randn(*s, dtype=torch.bfloat16) * 1.6)(S, F) * (S ** -0.5)),
            "b1": _w((lambda *s: torch.randn(*s, dtype=torch.bfloat16) * 1.6)(F) * 0.02),
            "w2": _w((lambda *s: torch.randn(*s, dtype=torch.bfloat16) * 1.6)(F, S) * (F ** -0.5)),
            "b2": _w((lambda *s: torch.randn(*s, dtype=torch.bfloat16) * 0.8)(S) * 0.02),
        }
    _B_in = _B_setup()

    return {
        "A_x": _A_in["x"],
        "A_k_cache": _A_in["k_cache"],
        "A_v_cache": _A_in["v_cache"],
        "A_wq": _A_in["wq"],
        "A_wo": _A_in["wo"],
        "B_x": _B_in["x"],
        "B_w1": _B_in["w1"],
        "B_b1": _B_in["b1"],
        "B_w2": _B_in["w2"],
        "B_b2": _B_in["b2"],
    }

def reference(A_x, A_k_cache, A_v_cache, A_wq, A_wo, B_x, B_w1, B_b1, B_w2, B_b2):
    def _A_ref(x, k_cache, v_cache, wq, wo):
        B, Sq, D = x.shape
        Hq, Dh = 32, 192
        Hkv = k_cache.shape[1]
        rep = Hq // Hkv
        q = (lambda x, *d: x.permute(*d))((x @ wq).reshape(B, Sq, Hq, Dh), 0, 2, 1, 3)
        k = (lambda x, n, axis: torch.repeat_interleave(x, n, dim=axis))(k_cache, rep, axis=1)
        v = (lambda x, n, axis: torch.repeat_interleave(x, n, dim=axis))(v_cache, rep, axis=1)
        scores = torch.einsum("bhqd,bhkd->bhqk", q, k) * (Dh ** -0.5)
        p = _softmax(scores, axis=-1)
        o = torch.einsum("bhqk,bhkd->bhqd", p, v)
        return (lambda x, *d: x.permute(*d))(o, 0, 2, 1, 3).reshape(B, Sq, Hq * Dh) @ wo

    def _B_ref(x, w1, b1, w2, b2):
        B, S, D = x.shape
        h = _layernorm(x, axis=-1)
        u = torch.einsum("bsd,sf->bdf", h, w1) + b1
        u = _gelu(u)
        y = torch.einsum("bdf,fs->bds", u, w2) + b2
        return (lambda x, *d: x.permute(*d))(y, 0, 2, 1)

    x = A_x
    h = x + _A_ref(_layernorm(x, axis=-1), A_k_cache, A_v_cache, A_wq, A_wo)
    h2 = h + _B_ref(_layernorm(h, axis=-1), B_w1, B_b1, B_w2, B_b2)
    return h2
```

```asm
; @launch grid=(256,1,1) block=(512,1,1) lds=55488
.amdgcn_target "amdgcn-amd-amdhsa--gfx950"
.text
.globl sequential_preLN__gqa_block_cached__mixer_token_mlp__decode_kernel
.p2align 8
.type sequential_preLN__gqa_block_cached__mixer_token_mlp__decode_kernel,@function
sequential_preLN__gqa_block_cached__mixer_token_mlp__decode_kernel:
    s_cmp_ge_u32 s2, 256
    s_cbranch_scc1 L_done
    s_load_dwordx16 s[16:31], s[0:1], 0
    s_load_dwordx8 s[32:39], s[0:1], 64
    s_load_dwordx2 s[40:41], s[0:1], 96
    v_and_b32 v1, 63, v0
    v_lshrrev_b32 v5, 6, v0
    v_lshrrev_b32 v6, 3, v1
    v_and_b32 v7, 7, v1
    v_readfirstlane_b32 s3, v5
    v_lshlrev_b32 v8, 4, v7
    v_mul_u32_u24 v2, 384, v6
    v_add_u32 v2, v2, v8
    v_mul_u32_u24 v3, 24576, v6
    v_add_u32 v3, v3, v8
    v_lshl_add_u32 v4, v7, 3, v6
    v_lshlrev_b32 v4, 2, v4
    v_lshlrev_b32 v9, 2, v1
    v_lshlrev_b32 v10, 2, v6
    v_mov_b32 v207, 0
    s_mov_b32 s14, 0xffff0000
    s_mov_b32 s12, 0x05040100
    s_mov_b32 s13, 0x07060302
    s_lshr_b32 s4, s2, 3
    s_and_b32 s5, s2, 7
    s_mov_b32 s6, 0
    s_lshl_b32 s7, s3, 3
    s_add_u32 s7, s7, s5
    s_mul_i32 s78, s4, 3145728
    s_lshl_b32 s79, s4, 12
    s_add_u32 s79, s79, 786432
    s_mul_i32 s76, s7, 6144
    s_add_u32 s76, s76, s78
    s_add_u32 s77, s76, 344064
    s_add_u32 s96, s76, 688128
    s_add_u32 s97, s76, 1032192
    s_mul_i32 s15, s3, 12288
    s_add_u32 s15, s15, 26112
    s_waitcnt lgkmcnt(0)
    s_mov_b32 s44, s18
    s_mov_b32 s45, s19
    s_mov_b32 s46, 0xc000000
    s_mov_b32 s47, 0x20000
    s_mov_b32 s48, s20
    s_mov_b32 s49, s21
    s_mov_b32 s50, 0xc000000
    s_mov_b32 s51, 0x20000
    s_mov_b32 s52, s18
    s_mov_b32 s53, s19
    s_mov_b32 s54, 0xc000000
    s_mov_b32 s55, 0x20000
    s_mov_b32 s56, s20
    s_mov_b32 s57, s21
    s_mov_b32 s58, 0xc000000
    s_mov_b32 s59, 0x20000
    s_mov_b32 s60, s40
    s_mov_b32 s61, s41
    s_mov_b32 s62, 0x200000
    s_mov_b32 s63, 0x20000
    s_mov_b32 s100, 0
    s_mov_b32 s101, 0
    v_mov_b32 v18, 0
    v_mov_b32 v19, 1
    s_cmp_eq_u32 s3, 7
    s_cbranch_scc1 L_comm
    s_cmp_eq_u32 s3, 6
    s_cbranch_scc1 L_pub
    s_cmp_eq_u32 s3, 5
    s_cbranch_scc1 L_idle
    s_setprio 2
    s_mov_b32 s64, s22
    s_mov_b32 s65, s23
    s_mov_b32 s66, 0x780000
    s_mov_b32 s67, 0x20000
    s_mov_b32 s72, s16
    s_mov_b32 s73, s17
    s_mov_b32 s74, 0xa00
    s_mov_b32 s75, 0x20000
    s_mul_i32 s9, s5, 160
    s_lshl_b32 s10, s3, 5
    s_add_u32 s9, s9, s10
    buffer_load_dword v232, v9, s[72:75], 0 offen offset:0
    buffer_load_dword v233, v9, s[72:75], 0 offen offset:256
    buffer_load_dword v234, v9, s[72:75], 0 offen offset:512
    buffer_load_dword v235, v9, s[72:75], 0 offen offset:768
    buffer_load_dword v236, v9, s[72:75], 0 offen offset:1024
    buffer_load_dword v242, v10, s[72:75], s9 offen offset:0
    buffer_load_dword v237, v9, s[72:75], 0 offen offset:1280
    buffer_load_dword v238, v9, s[72:75], 0 offen offset:1536
    buffer_load_dword v239, v9, s[72:75], 0 offen offset:1792
    buffer_load_dword v240, v9, s[72:75], 0 offen offset:2048
    buffer_load_dword v241, v9, s[72:75], 0 offen offset:2304
    buffer_load_dword v243, v10, s[72:75], s9 offen offset:1280
    s_mul_i32 s9, s5, 80
    s_lshl_b32 s10, s3, 4
    s_add_u32 s9, s9, s10
    s_mul_i32 s9, s9, 12288
    s_mul_i32 s10, s4, 384
    s_add_u32 s9, s9, s10
    s_add_u32 s10, s9, 12288
    buffer_load_dwordx4 v[208:211], v3, s[64:67], s9 offen offset:0 nt
    buffer_load_dwordx4 v[212:215], v3, s[64:67], s9 offen offset:128 nt
    buffer_load_dwordx4 v[216:219], v3, s[64:67], s9 offen offset:256 nt
    buffer_load_dwordx4 v[220:223], v3, s[64:67], s10 offen offset:0 nt
    buffer_load_dwordx4 v[224:227], v3, s[64:67], s10 offen offset:128 nt
    buffer_load_dwordx4 v[228:231], v3, s[64:67], s10 offen offset:256 nt
    buffer_load_dwordx4 v[56:59], v2, s[44:47], s76 offen offset:0 nt
    buffer_load_dwordx4 v[60:63], v2, s[44:47], s76 offen offset:128 nt
    buffer_load_dwordx4 v[64:67], v2, s[44:47], s76 offen offset:256 nt
    buffer_load_dwordx4 v[68:71], v2, s[44:47], s76 offen offset:3072 nt
    buffer_load_dwordx4 v[72:75], v2, s[44:47], s76 offen offset:3200 nt
    buffer_load_dwordx4 v[76:79], v2, s[44:47], s76 offen offset:3328 nt
    s_barrier
    s_waitcnt vmcnt(12)
    v_lshlrev_b32 v32, 16, v232
    v_and_b32 v33, s14, v232
    v_lshlrev_b32 v34, 16, v233
    v_and_b32 v35, s14, v233
    v_lshlrev_b32 v36, 16, v234
    v_and_b32 v37, s14, v234
    v_lshlrev_b32 v38, 16, v235
    v_and_b32 v39, s14, v235
    v_lshlrev_b32 v40, 16, v236
    v_and_b32 v41, s14, v236
    v_add_f32 v48, v32, v33
    v_add_f32 v48, v48, v34
    v_add_f32 v48, v48, v35
    v_add_f32 v48, v48, v36
    v_add_f32 v48, v48, v37
    v_add_f32 v48, v48, v38
    v_add_f32 v48, v48, v39
    v_add_f32 v48, v48, v40
    v_add_f32 v48, v48, v41
    s_nop 1
    v_add_f32_dpp v48, v48, v48 quad_perm:[1,0,3,2] row_mask:0xf bank_mask:0xf
    s_nop 1
    v_add_f32_dpp v48, v48, v48 quad_perm:[2,3,0,1] row_mask:0xf bank_mask:0xf
    s_nop 1
    v_add_f32_dpp v48, v48, v48 row_half_mirror row_mask:0xf bank_mask:0xf
    s_nop 1
    v_add_f32_dpp v48, v48, v48 row_mirror row_mask:0xf bank_mask:0xf
    v_mov_b32 v5, v48
    s_nop 1
    v_permlane16_swap_b32 v48, v5
    v_add_f32 v48, v48, v5
    v_mov_b32 v5, v48
    s_nop 1
    v_permlane32_swap_b32 v48, v5
    v_add_f32 v48, v48, v5
    v_mul_f32 v48, 0x3acccccd, v48
    v_sub_f32 v5, v32, v48
    v_mul_f32 v49, v5, v5
    v_sub_f32 v5, v33, v48
    v_fmac_f32 v49, v5, v5
    v_sub_f32 v5, v34, v48
    v_fmac_f32 v49, v5, v5
    v_sub_f32 v5, v35, v48
    v_fmac_f32 v49, v5, v5
    v_sub_f32 v5, v36, v48
    v_fmac_f32 v49, v5, v5
    v_sub_f32 v5, v37, v48
    v_fmac_f32 v49, v5, v5
    v_sub_f32 v5, v38, v48
    v_fmac_f32 v49, v5, v5
    v_sub_f32 v5, v39, v48
    v_fmac_f32 v49, v5, v5
    v_sub_f32 v5, v40, v48
    v_fmac_f32 v49, v5, v5
    v_sub_f32 v5, v41, v48
    v_fmac_f32 v49, v5, v5
    s_nop 1
    v_add_f32_dpp v49, v49, v49 quad_perm:[1,0,3,2] row_mask:0xf bank_mask:0xf
    s_nop 1
    v_add_f32_dpp v49, v49, v49 quad_perm:[2,3,0,1] row_mask:0xf bank_mask:0xf
    s_nop 1
    v_add_f32_dpp v49, v49, v49 row_half_mirror row_mask:0xf bank_mask:0xf
    s_nop 1
    v_add_f32_dpp v49, v49, v49 row_mirror row_mask:0xf bank_mask:0xf
    v_mov_b32 v5, v49
    s_nop 1
    v_permlane16_swap_b32 v49, v5
    v_add_f32 v49, v49, v5
    v_mov_b32 v5, v49
    s_nop 1
    v_permlane32_swap_b32 v49, v5
    v_add_f32 v49, v49, v5
    v_mul_f32 v49, 0x3acccccd, v49
    v_cvt_pk_bf16_f32 v5, v48, v49
    v_lshlrev_b32 v48, 16, v5
    v_and_b32 v49, s14, v5
    v_add_f32 v49, 0x3727c5ac, v49
    v_cvt_pk_bf16_f32 v5, v49, v49
    v_lshlrev_b32 v49, 16, v5
    v_sqrt_f32 v49, v49
    s_nop 0
    v_cvt_pk_bf16_f32 v5, v49, v49
    v_lshlrev_b32 v49, 16, v5
    v_rcp_f32 v50, v49
    v_lshlrev_b32 v52, 16, v242
    v_and_b32 v53, s14, v242
    v_sub_f32 v52, v52, v48
    v_sub_f32 v53, v53, v48
    v_cvt_pk_bf16_f32 v5, v52, v53
    v_lshlrev_b32 v52, 16, v5
    v_and_b32 v53, s14, v5
    v_mul_f32 v5, v52, v50
    v_fma_f32 v52, -v5, v49, v52
    v_fma_f32 v52, v52, v50, v5
    v_mul_f32 v6, v53, v50
    v_fma_f32 v53, -v6, v49, v53
    v_fma_f32 v53, v53, v50, v6
    v_cvt_pk_bf16_f32 v242, v52, v53
    v_lshlrev_b32 v32, 16, v237
    v_and_b32 v33, s14, v237
    v_lshlrev_b32 v34, 16, v238
    v_and_b32 v35, s14, v238
    v_lshlrev_b32 v36, 16, v239
    v_and_b32 v37, s14, v239
    v_lshlrev_b32 v38, 16, v240
    v_and_b32 v39, s14, v240
    v_lshlrev_b32 v40, 16, v241
    v_and_b32 v41, s14, v241
    v_add_f32 v48, v32, v33
    v_add_f32 v48, v48, v34
    v_add_f32 v48, v48, v35
    v_add_f32 v48, v48, v36
    v_add_f32 v48, v48, v37
    v_add_f32 v48, v48, v38
    v_add_f32 v48, v48, v39
    v_add_f32 v48, v48, v40
    v_add_f32 v48, v48, v41
    s_nop 1
    v_add_f32_dpp v48, v48, v48 quad_perm:[1,0,3,2] row_mask:0xf bank_mask:0xf
    s_nop 1
    v_add_f32_dpp v48, v48, v48 quad_perm:[2,3,0,1] row_mask:0xf bank_mask:0xf
    s_nop 1
    v_add_f32_dpp v48, v48, v48 row_half_mirror row_mask:0xf bank_mask:0xf
    s_nop 1
    v_add_f32_dpp v48, v48, v48 row_mirror row_mask:0xf bank_mask:0xf
    v_mov_b32 v5, v48
    s_nop 1
    v_permlane16_swap_b32 v48, v5
    v_add_f32 v48, v48, v5
    v_mov_b32 v5, v48
    s_nop 1
    v_permlane32_swap_b32 v48, v5
    v_add_f32 v48, v48, v5
    v_mul_f32 v48, 0x3acccccd, v48
    v_sub_f32 v5, v32, v48
    v_mul_f32 v49, v5, v5
    v_sub_f32 v5, v33, v48
    v_fmac_f32 v49, v5, v5
    v_sub_f32 v5, v34, v48
    v_fmac_f32 v49, v5, v5
    v_sub_f32 v5, v35, v48
    v_fmac_f32 v49, v5, v5
    v_sub_f32 v5, v36, v48
    v_fmac_f32 v49, v5, v5
    v_sub_f32 v5, v37, v48
    v_fmac_f32 v49, v5, v5
    v_sub_f32 v5, v38, v48
    v_fmac_f32 v49, v5, v5
    v_sub_f32 v5, v39, v48
    v_fmac_f32 v49, v5, v5
    v_sub_f32 v5, v40, v48
    v_fmac_f32 v49, v5, v5
    v_sub_f32 v5, v41, v48
    v_fmac_f32 v49, v5, v5
    s_nop 1
    v_add_f32_dpp v49, v49, v49 quad_perm:[1,0,3,2] row_mask:0xf bank_mask:0xf
    s_nop 1
    v_add_f32_dpp v49, v49, v49 quad_perm:[2,3,0,1] row_mask:0xf bank_mask:0xf
    s_nop 1
    v_add_f32_dpp v49, v49, v49 row_half_mirror row_mask:0xf bank_mask:0xf
    s_nop 1
    v_add_f32_dpp v49, v49, v49 row_mirror row_mask:0xf bank_mask:0xf
    v_mov_b32 v5, v49
    s_nop 1
    v_permlane16_swap_b32 v49, v5
    v_add_f32 v49, v49, v5
    v_mov_b32 v5, v49
    s_nop 1
    v_permlane32_swap_b32 v49, v5
    v_add_f32 v49, v49, v5
    v_mul_f32 v49, 0x3acccccd, v49
    v_cvt_pk_bf16_f32 v5, v48, v49
    v_lshlrev_b32 v48, 16, v5
    v_and_b32 v49, s14, v5
    v_add_f32 v49, 0x3727c5ac, v49
    v_cvt_pk_bf16_f32 v5, v49, v49
    v_lshlrev_b32 v49, 16, v5
    v_sqrt_f32 v49, v49
    s_nop 0
    v_cvt_pk_bf16_f32 v5, v49, v49
    v_lshlrev_b32 v49, 16, v5
    v_rcp_f32 v50, v49
    v_lshlrev_b32 v52, 16, v243
    v_and_b32 v53, s14, v243
    v_sub_f32 v52, v52, v48
    v_sub_f32 v53, v53, v48
    v_cvt_pk_bf16_f32 v5, v52, v53
    v_lshlrev_b32 v52, 16, v5
    v_and_b32 v53, s14, v5
    v_mul_f32 v5, v52, v50
    v_fma_f32 v52, -v5, v49, v52
    v_fma_f32 v52, v52, v50, v5
    v_mul_f32 v6, v53, v50
    v_fma_f32 v53, -v6, v49, v53
    v_fma_f32 v53, v53, v50, v6
    v_cvt_pk_bf16_f32 v243, v52, v53
    s_mul_i32 s9, s3, 1536
    v_add_u32 v11, s9, v4
    s_waitcnt vmcnt(6)
    v_mov_b32 v32, 0
    v_mov_b32 v33, 0
    v_mov_b32 v34, 0
    v_mov_b32 v35, 0
    v_mov_b32 v36, 0
    v_mov_b32 v37, 0
    v_mov_b32 v38, 0
    v_mov_b32 v39, 0
    v_mov_b32 v40, 0
    v_mov_b32 v41, 0
    v_mov_b32 v42, 0
    v_mov_b32 v43, 0
    v_mov_b32 v44, 0
    v_mov_b32 v45, 0
    v_mov_b32 v46, 0
    v_mov_b32 v47, 0
    v_mov_b32 v48, 0
    v_mov_b32 v49, 0
    v_mov_b32 v50, 0
    v_mov_b32 v51, 0
    v_mov_b32 v52, 0
    v_mov_b32 v53, 0
    v_mov_b32 v54, 0
    v_mov_b32 v55, 0
    v_perm_b32 v20, v220, v208, s12
    v_perm_b32 v21, v220, v208, s13
    v_dot2c_f32_bf16 v32, v20, v242
    v_dot2c_f32_bf16 v33, v21, v242
    v_perm_b32 v22, v221, v209, s12
    v_perm_b32 v23, v221, v209, s13
    v_dot2c_f32_bf16 v34, v22, v242
    v_dot2c_f32_bf16 v35, v23, v242
    v_perm_b32 v24, v222, v210, s12
    v_perm_b32 v25, v222, v210, s13
    v_dot2c_f32_bf16 v36, v24, v242
    v_dot2c_f32_bf16 v37, v25, v242
    v_perm_b32 v26, v223, v211, s12
    v_perm_b32 v27, v223, v211, s13
    v_dot2c_f32_bf16 v38, v26, v242
    v_dot2c_f32_bf16 v39, v27, v242
    v_perm_b32 v20, v224, v212, s12
    v_perm_b32 v21, v224, v212, s13
    v_dot2c_f32_bf16 v40, v20, v242
    v_dot2c_f32_bf16 v41, v21, v242
    v_perm_b32 v22, v225, v213, s12
    v_perm_b32 v23, v225, v213, s13
    v_dot2c_f32_bf16 v42, v22, v242
    v_dot2c_f32_bf16 v43, v23, v242
    v_perm_b32 v24, v226, v214, s12
    v_perm_b32 v25, v226, v214, s13
    v_dot2c_f32_bf16 v44, v24, v242
    v_dot2c_f32_bf16 v45, v25, v242
    v_perm_b32 v26, v227, v215, s12
    v_perm_b32 v27, v227, v215, s13
    v_dot2c_f32_bf16 v46, v26, v242
    v_dot2c_f32_bf16 v47, v27, v242
    v_perm_b32 v20, v228, v216, s12
    v_perm_b32 v21, v228, v216, s13
    v_dot2c_f32_bf16 v48, v20, v242
    v_dot2c_f32_bf16 v49, v21, v242
    v_perm_b32 v22, v229, v217, s12
    v_perm_b32 v23, v229, v217, s13
    v_dot2c_f32_bf16 v50, v22, v242
    v_dot2c_f32_bf16 v51, v23, v242
    v_perm_b32 v24, v230, v218, s12
    v_perm_b32 v25, v230, v218, s13
    v_dot2c_f32_bf16 v52, v24, v242
    v_dot2c_f32_bf16 v53, v25, v242
    v_perm_b32 v26, v231, v219, s12
    v_perm_b32 v27, v231, v219, s13
    v_dot2c_f32_bf16 v54, v26, v242
    v_dot2c_f32_bf16 v55, v27, v242
    v_permlane32_swap_b32 v32, v36
    v_permlane32_swap_b32 v33, v37
    v_permlane32_swap_b32 v34, v38
    v_permlane32_swap_b32 v35, v39
    v_permlane32_swap_b32 v40, v44
    v_permlane32_swap_b32 v41, v45
    v_permlane32_swap_b32 v42, v46
    v_permlane32_swap_b32 v43, v47
    v_permlane32_swap_b32 v48, v52
    v_permlane32_swap_b32 v49, v53
    v_permlane32_swap_b32 v50, v54
    v_permlane32_swap_b32 v51, v55
    v_add_f32 v32, v32, v36
    v_add_f32 v33, v33, v37
    v_add_f32 v34, v34, v38
    v_add_f32 v35, v35, v39
    v_add_f32 v40, v40, v44
    v_add_f32 v41, v41, v45
    v_add_f32 v42, v42, v46
    v_add_f32 v43, v43, v47
    v_add_f32 v48, v48, v52
    v_add_f32 v49, v49, v53
    v_add_f32 v50, v50, v54
    v_add_f32 v51, v51, v55
    v_permlane16_swap_b32 v32, v34
    v_permlane16_swap_b32 v33, v35
    v_permlane16_swap_b32 v40, v42
    v_permlane16_swap_b32 v41, v43
    v_permlane16_swap_b32 v48, v50
    v_permlane16_swap_b32 v49, v51
    v_add_f32 v32, v32, v34
    v_add_f32 v33, v33, v35
    v_add_f32 v40, v40, v42
    v_add_f32 v41, v41, v43
    v_add_f32 v48, v48, v50
    v_add_f32 v49, v49, v51
    v_add_f32_dpp v5, v32, v32 row_ror:8 row_mask:0xf bank_mask:0x3
    s_nop 1
    v_add_f32_dpp v5, v33, v33 row_ror:8 row_mask:0xf bank_mask:0xc
    v_add_f32_dpp v6, v40, v40 row_ror:8 row_mask:0xf bank_mask:0x3
    s_nop 1
    v_add_f32_dpp v6, v41, v41 row_ror:8 row_mask:0xf bank_mask:0xc
    v_add_f32_dpp v7, v48, v48 row_ror:8 row_mask:0xf bank_mask:0x3
    s_nop 1
    v_add_f32_dpp v7, v49, v49 row_ror:8 row_mask:0xf bank_mask:0xc
    ds_write_b32 v11, v5 offset:0
    ds_write_b32 v11, v6 offset:256
    ds_write_b32 v11, v7 offset:512
    v_mov_b32 v32, 0
    v_mov_b32 v33, 0
    v_mov_b32 v34, 0
    v_mov_b32 v35, 0
    v_mov_b32 v36, 0
    v_mov_b32 v37, 0
    v_mov_b32 v38, 0
    v_mov_b32 v39, 0
    v_mov_b32 v40, 0
    v_mov_b32 v41, 0
    v_mov_b32 v42, 0
    v_mov_b32 v43, 0
    v_mov_b32 v44, 0
    v_mov_b32 v45, 0
    v_mov_b32 v46, 0
    v_mov_b32 v47, 0
    v_mov_b32 v48, 0
    v_mov_b32 v49, 0
    v_mov_b32 v50, 0
    v_mov_b32 v51, 0
    v_mov_b32 v52, 0
    v_mov_b32 v53, 0
    v_mov_b32 v54, 0
    v_mov_b32 v55, 0
    v_perm_b32 v20, v220, v208, s12
    v_perm_b32 v21, v220, v208, s13
    v_dot2c_f32_bf16 v32, v20, v243
    v_dot2c_f32_bf16 v33, v21, v243
    v_perm_b32 v22, v221, v209, s12
    v_perm_b32 v23, v221, v209, s13
    v_dot2c_f32_bf16 v34, v22, v243
    v_dot2c_f32_bf16 v35, v23, v243
    v_perm_b32 v24, v222, v210, s12
    v_perm_b32 v25, v222, v210, s13
    v_dot2c_f32_bf16 v36, v24, v243
    v_dot2c_f32_bf16 v37, v25, v243
    v_perm_b32 v26, v223, v211, s12
    v_perm_b32 v27, v223, v211, s13
    v_dot2c_f32_bf16 v38, v26, v243
    v_dot2c_f32_bf16 v39, v27, v243
    v_perm_b32 v20, v224, v212, s12
    v_perm_b32 v21, v224, v212, s13
    v_dot2c_f32_bf16 v40, v20, v243
    v_dot2c_f32_bf16 v41, v21, v243
    v_perm_b32 v22, v225, v213, s12
    v_perm_b32 v23, v225, v213, s13
    v_dot2c_f32_bf16 v42, v22, v243
    v_dot2c_f32_bf16 v43, v23, v243
    v_perm_b32 v24, v226, v214, s12
    v_perm_b32 v25, v226, v214, s13
    v_dot2c_f32_bf16 v44, v24, v243
    v_dot2c_f32_bf16 v45, v25, v243
    v_perm_b32 v26, v227, v215, s12
    v_perm_b32 v27, v227, v215, s13
    v_dot2c_f32_bf16 v46, v26, v243
    v_dot2c_f32_bf16 v47, v27, v243
    v_perm_b32 v20, v228, v216, s12
    v_perm_b32 v21, v228, v216, s13
    v_dot2c_f32_bf16 v48, v20, v243
    v_dot2c_f32_bf16 v49, v21, v243
    v_perm_b32 v22, v229, v217, s12
    v_perm_b32 v23, v229, v217, s13
    v_dot2c_f32_bf16 v50, v22, v243
    v_dot2c_f32_bf16 v51, v23, v243
    v_perm_b32 v24, v230, v218, s12
    v_perm_b32 v25, v230, v218, s13
    v_dot2c_f32_bf16 v52, v24, v243
    v_dot2c_f32_bf16 v53, v25, v243
    v_perm_b32 v26, v231, v219, s12
    v_perm_b32 v27, v231, v219, s13
    v_dot2c_f32_bf16 v54, v26, v243
    v_dot2c_f32_bf16 v55, v27, v243
    v_permlane32_swap_b32 v32, v36
    v_permlane32_swap_b32 v33, v37
    v_permlane32_swap_b32 v34, v38
    v_permlane32_swap_b32 v35, v39
    v_permlane32_swap_b32 v40, v44
    v_permlane32_swap_b32 v41, v45
    v_permlane32_swap_b32 v42, v46
    v_permlane32_swap_b32 v43, v47
    v_permlane32_swap_b32 v48, v52
    v_permlane32_swap_b32 v49, v53
    v_permlane32_swap_b32 v50, v54
    v_permlane32_swap_b32 v51, v55
    v_add_f32 v32, v32, v36
    v_add_f32 v33, v33, v37
    v_add_f32 v34, v34, v38
    v_add_f32 v35, v35, v39
    v_add_f32 v40, v40, v44
    v_add_f32 v41, v41, v45
    v_add_f32 v42, v42, v46
    v_add_f32 v43, v43, v47
    v_add_f32 v48, v48, v52
    v_add_f32 v49, v49, v53
    v_add_f32 v50, v50, v54
    v_add_f32 v51, v51, v55
    v_permlane16_swap_b32 v32, v34
    v_permlane16_swap_b32 v33, v35
    v_permlane16_swap_b32 v40, v42
    v_permlane16_swap_b32 v41, v43
    v_permlane16_swap_b32 v48, v50
    v_permlane16_swap_b32 v49, v51
    v_add_f32 v32, v32, v34
    v_add_f32 v33, v33, v35
    v_add_f32 v40, v40, v42
    v_add_f32 v41, v41, v43
    v_add_f32 v48, v48, v50
    v_add_f32 v49, v49, v51
    v_add_f32_dpp v5, v32, v32 row_ror:8 row_mask:0xf bank_mask:0x3
    s_nop 1
    v_add_f32_dpp v5, v33, v33 row_ror:8 row_mask:0xf bank_mask:0xc
    v_add_f32_dpp v6, v40, v40 row_ror:8 row_mask:0xf bank_mask:0x3
    s_nop 1
    v_add_f32_dpp v6, v41, v41 row_ror:8 row_mask:0xf bank_mask:0xc
    v_add_f32_dpp v7, v48, v48 row_ror:8 row_mask:0xf bank_mask:0x3
    s_nop 1
    v_add_f32_dpp v7, v49, v49 row_ror:8 row_mask:0xf bank_mask:0xc
    ds_write_b32 v11, v5 offset:768
    ds_write_b32 v11, v6 offset:1024
    ds_write_b32 v11, v7 offset:1280
    s_mov_b64 exec, 1
    ds_add_u32 v18, v19 offset:20864
    s_mov_b64 exec, -1
    s_setprio 0
    s_branch L_paced
L_comm:
    s_setprio 3
    buffer_load_dword v15, off, s[60:63], s79 offset:256 sc1
    v_lshlrev_b32 v11, 4, v1
    v_add_u32 v12, 28, v1
    v_lshlrev_b32 v13, 3, v12
    v_add_u32 v13, s5, v13
    v_cmp_gt_u32 vcc, 64, v1
    s_nop 1
    v_cndmask_b32 v13, -1, v13, vcc
    ds_write_b32 v9, v13 offset:20896
    v_mov_b32 v32, -1
    v_mov_b32 v33, -1
    v_mov_b32 v34, -1
    v_mov_b32 v35, -1
    ds_write_b128 v11, v[32:35] offset:21152
    ds_write_b128 v11, v[32:35] offset:22176
    ds_write_b128 v11, v[32:35] offset:23200
    ds_write_b128 v11, v[32:35] offset:24224
    v_mov_b32 v16, 0
    v_mov_b32 v17, 0
    ds_write_b64 v18, v[16:17] offset:20864
    ds_write_b64 v18, v[16:17] offset:20872
    s_waitcnt lgkmcnt(0)
    s_barrier
    s_waitcnt vmcnt(0)
    v_add_u32 v15, 1, v15
    s_mov_b32 s94, 262144
L_cwait7:
    ds_read_b32 v14, v18 offset:20864
    s_waitcnt lgkmcnt(0)
    v_readfirstlane_b32 s11, v14
    s_nop 0
    s_cmp_ge_u32 s11, 5
    s_cbranch_scc1 L_cgot7
    s_sleep 1
    s_sub_u32 s94, s94, 1
    s_cmp_lg_u32 s94, 0
    s_cbranch_scc1 L_cwait7
L_cgot7:
    s_mov_b32 s94, 262144
L_qok:
    s_mul_i32 s9, s4, 24576
    buffer_load_dwordx4 v[104:107], v11, s[60:63], s9 offen offset:0 sc1
    buffer_load_dwordx4 v[108:111], v11, s[60:63], s9 offen offset:1024 sc1
    buffer_load_dwordx4 v[112:115], v11, s[60:63], s9 offen offset:2048 sc1
    s_add_u32 s9, s9, 3072
    buffer_load_dwordx4 v[116:119], v11, s[60:63], s9 offen offset:0 sc1
    buffer_load_dwordx4 v[120:123], v11, s[60:63], s9 offen offset:1024 sc1
    buffer_load_dwordx4 v[124:127], v11, s[60:63], s9 offen offset:2048 sc1
    s_add_u32 s9, s9, 3072
    buffer_load_dwordx4 v[128:131], v11, s[60:63], s9 offen offset:0 sc1
    buffer_load_dwordx4 v[132:135], v11, s[60:63], s9 offen offset:1024 sc1
    buffer_load_dwordx4 v[136:139], v11, s[60:63], s9 offen offset:2048 sc1
    s_add_u32 s9, s9, 3072
    buffer_load_dwordx4 v[140:143], v11, s[60:63], s9 offen offset:0 sc1
    buffer_load_dwordx4 v[144:147], v11, s[60:63], s9 offen offset:1024 sc1
    buffer_load_dwordx4 v[148:151], v11, s[60:63], s9 offen offset:2048 sc1
    s_add_u32 s9, s9, 3072
    buffer_load_dwordx4 v[152:155], v11, s[60:63], s9 offen offset:0 sc1
    buffer_load_dwordx4 v[156:159], v11, s[60:63], s9 offen offset:1024 sc1
    buffer_load_dwordx4 v[160:163], v11, s[60:63], s9 offen offset:2048 sc1
    s_add_u32 s9, s9, 3072
    buffer_load_dwordx4 v[164:167], v11, s[60:63], s9 offen offset:0 sc1
    buffer_load_dwordx4 v[168:171], v11, s[60:63], s9 offen offset:1024 sc1
    buffer_load_dwordx4 v[172:175], v11, s[60:63], s9 offen offset:2048 sc1
    s_add_u32 s9, s9, 3072
    buffer_load_dwordx4 v[176:179], v11, s[60:63], s9 offen offset:0 sc1
    buffer_load_dwordx4 v[180:183], v11, s[60:63], s9 offen offset:1024 sc1
    buffer_load_dwordx4 v[184:187], v11, s[60:63], s9 offen offset:2048 sc1
    s_add_u32 s9, s9, 3072
    buffer_load_dwordx4 v[188:191], v11, s[60:63], s9 offen offset:0 sc1
    buffer_load_dwordx4 v[192:195], v11, s[60:63], s9 offen offset:1024 sc1
    buffer_load_dwordx4 v[196:199], v11, s[60:63], s9 offen offset:2048 sc1
    s_waitcnt vmcnt(0)
    v_xor_b32 v13, v15, v105
    v_xor_b32 v14, v15, v107
    v_or_b32 v13, v13, v14
    v_xor_b32 v14, v15, v109
    v_or_b32 v13, v13, v14
    v_xor_b32 v14, v15, v111
    v_or_b32 v13, v13, v14
    v_xor_b32 v14, v15, v113
    v_or_b32 v13, v13, v14
    v_xor_b32 v14, v15, v115
    v_or_b32 v13, v13, v14
    v_xor_b32 v14, v15, v117
    v_or_b32 v13, v13, v14
    v_xor_b32 v14, v15, v119
    v_or_b32 v13, v13, v14
    v_xor_b32 v14, v15, v121
    v_or_b32 v13, v13, v14
    v_xor_b32 v14, v15, v123
    v_or_b32 v13, v13, v14
    v_xor_b32 v14, v15, v125
    v_or_b32 v13, v13, v14
    v_xor_b32 v14, v15, v127
    v_or_b32 v13, v13, v14
    v_xor_b32 v14, v15, v129
    v_or_b32 v13, v13, v14
    v_xor_b32 v14, v15, v131
    v_or_b32 v13, v13, v14
    v_xor_b32 v14, v15, v133
    v_or_b32 v13, v13, v14
    v_xor_b32 v14, v15, v135
    v_or_b32 v13, v13, v14
    v_xor_b32 v14, v15, v137
    v_or_b32 v13, v13, v14
    v_xor_b32 v14, v15, v139
    v_or_b32 v13, v13, v14
    v_xor_b32 v14, v15, v141
    v_or_b32 v13, v13, v14
    v_xor_b32 v14, v15, v143
    v_or_b32 v13, v13, v14
    v_xor_b32 v14, v15, v145
    v_or_b32 v13, v13, v14
    v_xor_b32 v14, v15, v147
    v_or_b32 v13, v13, v14
    v_xor_b32 v14, v15, v149
    v_or_b32 v13, v13, v14
    v_xor_b32 v14, v15, v151
    v_or_b32 v13, v13, v14
    v_xor_b32 v14, v15, v153
    v_or_b32 v13, v13, v14
    v_xor_b32 v14, v15, v155
    v_or_b32 v13, v13, v14
    v_xor_b32 v14, v15, v157
    v_or_b32 v13, v13, v14
    v_xor_b32 v14, v15, v159
    v_or_b32 v13, v13, v14
    v_xor_b32 v14, v15, v161
    v_or_b32 v13, v13, v14
    v_xor_b32 v14, v15, v163
    v_or_b32 v13, v13, v14
    v_xor_b32 v14, v15, v165
    v_or_b32 v13, v13, v14
    v_xor_b32 v14, v15, v167
    v_or_b32 v13, v13, v14
    v_xor_b32 v14, v15, v169
    v_or_b32 v13, v13, v14
    v_xor_b32 v14, v15, v171
    v_or_b32 v13, v13, v14
    v_xor_b32 v14, v15, v173
    v_or_b32 v13, v13, v14
    v_xor_b32 v14, v15, v175
    v_or_b32 v13, v13, v14
    v_xor_b32 v14, v15, v177
    v_or_b32 v13, v13, v14
    v_xor_b32 v14, v15, v179
    v_or_b32 v13, v13, v14
    v_xor_b32 v14, v15, v181
    v_or_b32 v13, v13, v14
    v_xor_b32 v14, v15, v183
    v_or_b32 v13, v13, v14
    v_xor_b32 v14, v15, v185
    v_or_b32 v13, v13, v14
    v_xor_b32 v14, v15, v187
    v_or_b32 v13, v13, v14
    v_xor_b32 v14, v15, v189
    v_or_b32 v13, v13, v14
    v_xor_b32 v14, v15, v191
    v_or_b32 v13, v13, v14
    v_xor_b32 v14, v15, v193
    v_or_b32 v13, v13, v14
    v_xor_b32 v14, v15, v195
    v_or_b32 v13, v13, v14
    v_xor_b32 v14, v15, v197
    v_or_b32 v13, v13, v14
    v_xor_b32 v14, v15, v199
    v_or_b32 v13, v13, v14
    v_cmp_ne_u32 vcc, 0, v13
    s_cbranch_vccz L_qgot
    s_sub_u32 s94, s94, 1
    s_cmp_lg_u32 s94, 0
    s_cbranch_scc1 L_qok
L_qgot:
    v_add_f32 v104, v104, v116
    v_add_f32 v106, v106, v118
    v_add_f32 v108, v108, v120
    v_add_f32 v110, v110, v122
    v_add_f32 v112, v112, v124
    v_add_f32 v114, v114, v126
    v_add_f32 v104, v104, v128
    v_add_f32 v106, v106, v130
    v_add_f32 v108, v108, v132
    v_add_f32 v110, v110, v134
    v_add_f32 v112, v112, v136
    v_add_f32 v114, v114, v138
    v_add_f32 v104, v104, v140
    v_add_f32 v106, v106, v142
    v_add_f32 v108, v108, v144
    v_add_f32 v110, v110, v146
    v_add_f32 v112, v112, v148
    v_add_f32 v114, v114, v150
    v_add_f32 v104, v104, v152
    v_add_f32 v106, v106, v154
    v_add_f32 v108, v108, v156
    v_add_f32 v110, v110, v158
    v_add_f32 v112, v112, v160
    v_add_f32 v114, v114, v162
    v_add_f32 v104, v104, v164
    v_add_f32 v106, v106, v166
    v_add_f32 v108, v108, v168
    v_add_f32 v110, v110, v170
    v_add_f32 v112, v112, v172
    v_add_f32 v114, v114, v174
    v_add_f32 v104, v104, v176
    v_add_f32 v106, v106, v178
    v_add_f32 v108, v108, v180
    v_add_f32 v110, v110, v182
    v_add_f32 v112, v112, v184
    v_add_f32 v114, v114, v186
    v_add_f32 v104, v104, v188
    v_add_f32 v106, v106, v190
    v_add_f32 v108, v108, v192
    v_add_f32 v110, v110, v194
    v_add_f32 v112, v112, v196
    v_add_f32 v114, v114, v198
    v_cvt_pk_bf16_f32 v5, v104, v106
    v_cvt_pk_bf16_f32 v6, v108, v110
    v_cvt_pk_bf16_f32 v7, v112, v114
    ds_write_b32 v9, v5 offset:7680
    ds_write_b32 v9, v6 offset:7936
    ds_write_b32 v9, v7 offset:8192
    ds_write_b32 v18, v19 offset:20868
    v_mov_b32 v242, v15
    s_waitcnt lgkmcnt(0)
    s_mov_b32 s68, s38
    s_mov_b32 s69, s39
    s_mov_b32 s70, 0x80
    s_mov_b32 s71, 0x20000
    s_lshl_b32 s10, s4, 2
    s_mov_b32 s94, 262144
L_qpoll:
    buffer_load_dword v13, off, s[68:71], s10 sc1
    s_waitcnt vmcnt(0)
    v_readfirstlane_b32 s11, v13
    s_nop 0
    s_cmp_ge_u32 s11, 8
    s_cbranch_scc1 L_disp0
    s_sleep 8
    s_sub_u32 s94, s94, 1
    s_cmp_lg_u32 s94, 0
    s_cbranch_scc1 L_qpoll
L_disp0:
    s_mov_b32 s8, 64
    s_mov_b32 s9, 8
    s_mov_b32 s94, 4194304
L_disp:
    ds_read_b32 v14, v18 offset:20872
    s_waitcnt lgkmcnt(0)
    v_readfirstlane_b32 s10, v14
    s_nop 0
    s_sub_i32 s10, s8, s10
    s_cmp_le_i32 s10, s9
    s_cbranch_scc1 L_fetch
    s_sleep 2
    s_sub_u32 s94, s94, 1
    s_cmp_lg_u32 s94, 0
    s_cbranch_scc1 L_disp
L_fetch:
    s_mov_b64 exec, 1
    v_mov_b32 v13, s9
    buffer_atomic_add v13, off, s[60:63], s79 sc0 sc1
    s_mov_b64 exec, -1
    s_lshl_b32 s10, s8, 2
    v_add_u32 v14, s10, v9
    s_waitcnt vmcnt(0)
    v_readfirstlane_b32 s11, v13
    s_nop 1
    v_add_u32 v13, s11, v1
    s_bfm_b64 exec, s9, 0
    ds_write_b32 v14, v13 offset:20896
    s_mov_b64 exec, -1
    s_add_u32 s8, s8, s9
    s_add_u32 s11, s11, s9
    s_cmp_ge_u32 s11, 1024
    s_cbranch_scc1 L_dend
    s_sub_u32 s11, 1024, s11
    s_lshr_b32 s11, s11, 4
    s_min_u32 s11, s11, 8
    s_max_u32 s9, s11, 2
    s_cmp_lt_u32 s8, 1000
    s_cbranch_scc1 L_disp
L_dend:
    s_lshl_b32 s10, s8, 2
    v_add_u32 v14, s10, v9
    v_mov_b32 v13, 0x7fffffff
    s_mov_b64 exec, 0xff
    ds_write_b32 v14, v13 offset:20896
    s_mov_b64 exec, -1
    s_mov_b32 s7, 0x7fff
    s_branch L_join7
L_pub:
    s_setprio 3
    s_mov_b32 s68, s38
    s_mov_b32 s69, s39
    s_mov_b32 s70, 0x80
    s_mov_b32 s71, 0x20000
    buffer_load_dword v15, off, s[60:63], s79 offset:256 sc1
    v_mov_b32 v32, -1
    v_mov_b32 v33, -1
    v_mov_b32 v34, -1
    v_mov_b32 v35, -1
    v_lshlrev_b32 v11, 4, v1
    v_lshlrev_b32 v12, 3, v1
    s_lshl_b32 s9, s2, 11
    s_add_u32 s9, s9, 1114112
    buffer_store_dwordx4 v[32:35], v11, s[60:63], s9 offen sc1
    buffer_store_dwordx4 v[32:35], v11, s[60:63], s9 offen offset:1024 sc1
    s_lshl_b32 s9, s2, 9
    s_add_u32 s9, s9, 983040
    buffer_store_dwordx2 v[32:33], v12, s[60:63], s9 offen sc1
    s_lshl_b32 s9, s2, 2
    s_add_u32 s9, s9, 917504
    v_lshlrev_b32 v14, 12, v1
    s_mov_b64 exec, 0xff
    buffer_store_dword v32, v14, s[60:63], s9 offen sc1
    s_cmp_eq_u32 s5, 0
    s_cselect_b32 s62, 0x200000, 0
    s_mov_b64 exec, 1
    v_mov_b32 v13, 736
    buffer_store_dword v13, off, s[60:63], s79 sc1
    s_mov_b32 s62, 0x200000
    s_mov_b64 exec, -1
    s_barrier
    s_waitcnt vmcnt(5)
    v_add_u32 v15, 1, v15
    s_mul_i32 s95, s2, 3072
    s_mov_b32 s94, 262144
L_cwait:
    ds_read_b32 v14, v18 offset:20864
    s_waitcnt lgkmcnt(0)
    v_readfirstlane_b32 s11, v14
    s_nop 0
    s_cmp_ge_u32 s11, 5
    s_cbranch_scc1 L_cgot
    s_sleep 1
    s_sub_u32 s94, s94, 1
    s_cmp_lg_u32 s94, 0
    s_cbranch_scc1 L_cwait
L_cgot:
    ds_read_b64 v[152:153], v12 offset:0
    ds_read_b64 v[154:155], v12 offset:512
    ds_read_b64 v[156:157], v12 offset:1024
    ds_read_b64 v[158:159], v12 offset:1536
    ds_read_b64 v[160:161], v12 offset:2048
    ds_read_b64 v[162:163], v12 offset:2560
    ds_read_b64 v[164:165], v12 offset:3072
    ds_read_b64 v[166:167], v12 offset:3584
    ds_read_b64 v[168:169], v12 offset:4096
    ds_read_b64 v[170:171], v12 offset:4608
    ds_read_b64 v[172:173], v12 offset:5120
    ds_read_b64 v[174:175], v12 offset:5632
    ds_read_b64 v[176:177], v12 offset:6144
    ds_read_b64 v[178:179], v12 offset:6656
    ds_read_b64 v[180:181], v12 offset:7168
    s_waitcnt lgkmcnt(0)
    v_add_f32 v152, v152, v158
    v_add_f32 v153, v153, v159
    v_add_f32 v154, v154, v160
    v_add_f32 v155, v155, v161
    v_add_f32 v156, v156, v162
    v_add_f32 v157, v157, v163
    v_add_f32 v152, v152, v164
    v_add_f32 v153, v153, v165
    v_add_f32 v154, v154, v166
    v_add_f32 v155, v155, v167
    v_add_f32 v156, v156, v168
    v_add_f32 v157, v157, v169
    v_add_f32 v152, v152, v170
    v_add_f32 v153, v153, v171
    v_add_f32 v154, v154, v172
    v_add_f32 v155, v155, v173
    v_add_f32 v156, v156, v174
    v_add_f32 v157, v157, v175
    v_add_f32 v152, v152, v176
    v_add_f32 v153, v153, v177
    v_add_f32 v154, v154, v178
    v_add_f32 v155, v155, v179
    v_add_f32 v156, v156, v180
    v_add_f32 v157, v157, v181
    v_mov_b32 v36, v152
    v_mov_b32 v37, v15
    v_mov_b32 v38, v153
    v_mov_b32 v39, v15
    v_mov_b32 v40, v154
    v_mov_b32 v41, v15
    v_mov_b32 v42, v155
    v_mov_b32 v43, v15
    v_mov_b32 v44, v156
    v_mov_b32 v45, v15
    v_mov_b32 v46, v157
    v_mov_b32 v47, v15
    buffer_store_dwordx4 v[36:39], v11, s[60:63], s95 offen offset:0 sc1
    buffer_store_dwordx4 v[40:43], v11, s[60:63], s95 offen offset:1024 sc1
    buffer_store_dwordx4 v[44:47], v11, s[60:63], s95 offen offset:2048 sc1
    s_setprio 0
    buffer_load_dwordx4 v[56:59], v2, s[44:47], s76 offen offset:0 nt
    buffer_load_dwordx4 v[60:63], v2, s[44:47], s76 offen offset:128 nt
    buffer_load_dwordx4 v[64:67], v2, s[44:47], s76 offen offset:256 nt
    buffer_load_dwordx4 v[68:71], v2, s[44:47], s76 offen offset:3072 nt
    buffer_load_dwordx4 v[72:75], v2, s[44:47], s76 offen offset:3200 nt
    buffer_load_dwordx4 v[76:79], v2, s[44:47], s76 offen offset:3328 nt
    s_waitcnt vmcnt(9)
    s_lshl_b32 s10, s4, 2
    s_mov_b64 exec, 1
    buffer_atomic_add v19, off, s[68:71], s10 sc1
    s_mov_b64 exec, -1
    s_branch L_paced
L_idle:
    s_barrier
    buffer_load_dwordx4 v[56:59], v2, s[44:47], s76 offen offset:0 nt
    buffer_load_dwordx4 v[60:63], v2, s[44:47], s76 offen offset:128 nt
    buffer_load_dwordx4 v[64:67], v2, s[44:47], s76 offen offset:256 nt
    buffer_load_dwordx4 v[68:71], v2, s[44:47], s76 offen offset:3072 nt
    buffer_load_dwordx4 v[72:75], v2, s[44:47], s76 offen offset:3200 nt
    buffer_load_dwordx4 v[76:79], v2, s[44:47], s76 offen offset:3328 nt
L_paced:
    ds_read_b32 v14, v18 offset:20868
    s_waitcnt vmcnt(3) lgkmcnt(0)
    v_readfirstlane_b32 s9, v14
    s_nop 0
    s_cmp_lg_u32 s9, 0
    s_cbranch_scc1 L_rest2
    buffer_load_dwordx4 v[80:83], v2, s[48:51], s76 offen offset:0 nt
    buffer_load_dwordx4 v[84:87], v2, s[48:51], s76 offen offset:128 nt
    buffer_load_dwordx4 v[88:91], v2, s[48:51], s76 offen offset:256 nt
    ds_read_b32 v14, v18 offset:20868
    s_waitcnt vmcnt(3) lgkmcnt(0)
    v_readfirstlane_b32 s9, v14
    s_nop 0
    s_cmp_lg_u32 s9, 0
    s_cbranch_scc1 L_rest3
    buffer_load_dwordx4 v[92:95], v2, s[48:51], s76 offen offset:3072 nt
    buffer_load_dwordx4 v[96:99], v2, s[48:51], s76 offen offset:3200 nt
    buffer_load_dwordx4 v[100:103], v2, s[48:51], s76 offen offset:3328 nt
    ds_read_b32 v14, v18 offset:20868
    s_waitcnt vmcnt(3) lgkmcnt(0)
    v_readfirstlane_b32 s9, v14
    s_nop 0
    s_cmp_lg_u32 s9, 0
    s_cbranch_scc1 L_rest4
    buffer_load_dwordx4 v[104:107], v2, s[44:47], s77 offen offset:0 nt
    buffer_load_dwordx4 v[108:111], v2, s[44:47], s77 offen offset:128 nt
    buffer_load_dwordx4 v[112:115], v2, s[44:47], s77 offen offset:256 nt
    ds_read_b32 v14, v18 offset:20868
    s_waitcnt vmcnt(3) lgkmcnt(0)
    v_readfirstlane_b32 s9, v14
    s_nop 0
    s_cmp_lg_u32 s9, 0
    s_cbranch_scc1 L_rest5
    buffer_load_dwordx4 v[116:119], v2, s[44:47], s77 offen offset:3072 nt
    buffer_load_dwordx4 v[120:123], v2, s[44:47], s77 offen offset:3200 nt
    buffer_load_dwordx4 v[124:127], v2, s[44:47], s77 offen offset:3328 nt
    ds_read_b32 v14, v18 offset:20868
    s_waitcnt vmcnt(3) lgkmcnt(0)
    v_readfirstlane_b32 s9, v14
    s_nop 0
    s_cmp_lg_u32 s9, 0
    s_cbranch_scc1 L_rest6
    buffer_load_dwordx4 v[128:131], v2, s[48:51], s77 offen offset:0 nt
    buffer_load_dwordx4 v[132:135], v2, s[48:51], s77 offen offset:128 nt
    buffer_load_dwordx4 v[136:139], v2, s[48:51], s77 offen offset:256 nt
    ds_read_b32 v14, v18 offset:20868
    s_waitcnt vmcnt(3) lgkmcnt(0)
    v_readfirstlane_b32 s9, v14
    s_nop 0
    s_cmp_lg_u32 s9, 0
    s_cbranch_scc1 L_rest7
    buffer_load_dwordx4 v[140:143], v2, s[48:51], s77 offen offset:3072 nt
    buffer_load_dwordx4 v[144:147], v2, s[48:51], s77 offen offset:3200 nt
    buffer_load_dwordx4 v[148:151], v2, s[48:51], s77 offen offset:3328 nt
    ds_read_b32 v14, v18 offset:20868
    s_waitcnt vmcnt(3) lgkmcnt(0)
    v_readfirstlane_b32 s9, v14
    s_nop 0
    s_cmp_lg_u32 s9, 0
    s_cbranch_scc1 L_rest8
    buffer_load_dwordx4 v[152:155], v2, s[44:47], s96 offen offset:0 nt
    buffer_load_dwordx4 v[156:159], v2, s[44:47], s96 offen offset:128 nt
    buffer_load_dwordx4 v[160:163], v2, s[44:47], s96 offen offset:256 nt
    ds_read_b32 v14, v18 offset:20868
    s_waitcnt vmcnt(3) lgkmcnt(0)
    v_readfirstlane_b32 s9, v14
    s_nop 0
    s_cmp_lg_u32 s9, 0
    s_cbranch_scc1 L_rest9
    buffer_load_dwordx4 v[164:167], v2, s[44:47], s96 offen offset:3072 nt
    buffer_load_dwordx4 v[168:171], v2, s[44:47], s96 offen offset:3200 nt
    buffer_load_dwordx4 v[172:175], v2, s[44:47], s96 offen offset:3328 nt
    ds_read_b32 v14, v18 offset:20868
    s_waitcnt vmcnt(3) lgkmcnt(0)
    v_readfirstlane_b32 s9, v14
    s_nop 0
    s_cmp_lg_u32 s9, 0
    s_cbranch_scc1 L_rest10
    buffer_load_dwordx4 v[176:179], v2, s[48:51], s96 offen offset:0 nt
    buffer_load_dwordx4 v[180:183], v2, s[48:51], s96 offen offset:128 nt
    buffer_load_dwordx4 v[184:187], v2, s[48:51], s96 offen offset:256 nt
    ds_read_b32 v14, v18 offset:20868
    s_waitcnt vmcnt(3) lgkmcnt(0)
    v_readfirstlane_b32 s9, v14
    s_nop 0
    s_cmp_lg_u32 s9, 0
    s_cbranch_scc1 L_rest11
    buffer_load_dwordx4 v[188:191], v2, s[48:51], s96 offen offset:3072 nt
    buffer_load_dwordx4 v[192:195], v2, s[48:51], s96 offen offset:3200 nt
    buffer_load_dwordx4 v[196:199], v2, s[48:51], s96 offen offset:3328 nt
    s_mov_b32 s94, 262144
L_qspin:
    ds_read_b32 v14, v18 offset:20868
    s_waitcnt lgkmcnt(0)
    v_readfirstlane_b32 s9, v14
    s_nop 0
    s_cmp_lg_u32 s9, 0
    s_cbranch_scc1 L_join
    s_sleep 2
    s_sub_u32 s94, s94, 1
    s_cmp_lg_u32 s94, 0
    s_cbranch_scc1 L_qspin
    s_branch L_join
L_rest2:
    buffer_load_dwordx4 v[80:83], v2, s[48:51], s76 offen offset:0 nt
    buffer_load_dwordx4 v[84:87], v2, s[48:51], s76 offen offset:128 nt
    buffer_load_dwordx4 v[88:91], v2, s[48:51], s76 offen offset:256 nt
L_rest3:
    buffer_load_dwordx4 v[92:95], v2, s[48:51], s76 offen offset:3072 nt
    buffer_load_dwordx4 v[96:99], v2, s[48:51], s76 offen offset:3200 nt
    buffer_load_dwordx4 v[100:103], v2, s[48:51], s76 offen offset:3328 nt
L_rest4:
    buffer_load_dwordx4 v[104:107], v2, s[44:47], s77 offen offset:0 nt
    buffer_load_dwordx4 v[108:111], v2, s[44:47], s77 offen offset:128 nt
    buffer_load_dwordx4 v[112:115], v2, s[44:47], s77 offen offset:256 nt
L_rest5:
    buffer_load_dwordx4 v[116:119], v2, s[44:47], s77 offen offset:3072 nt
    buffer_load_dwordx4 v[120:123], v2, s[44:47], s77 offen offset:3200 nt
    buffer_load_dwordx4 v[124:127], v2, s[44:47], s77 offen offset:3328 nt
L_rest6:
    buffer_load_dwordx4 v[128:131], v2, s[48:51], s77 offen offset:0 nt
    buffer_load_dwordx4 v[132:135], v2, s[48:51], s77 offen offset:128 nt
    buffer_load_dwordx4 v[136:139], v2, s[48:51], s77 offen offset:256 nt
L_rest7:
    buffer_load_dwordx4 v[140:143], v2, s[48:51], s77 offen offset:3072 nt
    buffer_load_dwordx4 v[144:147], v2, s[48:51], s77 offen offset:3200 nt
    buffer_load_dwordx4 v[148:151], v2, s[48:51], s77 offen offset:3328 nt
L_rest8:
    buffer_load_dwordx4 v[152:155], v2, s[44:47], s96 offen offset:0 nt
    buffer_load_dwordx4 v[156:159], v2, s[44:47], s96 offen offset:128 nt
    buffer_load_dwordx4 v[160:163], v2, s[44:47], s96 offen offset:256 nt
L_rest9:
    buffer_load_dwordx4 v[164:167], v2, s[44:47], s96 offen offset:3072 nt
    buffer_load_dwordx4 v[168:171], v2, s[44:47], s96 offen offset:3200 nt
    buffer_load_dwordx4 v[172:175], v2, s[44:47], s96 offen offset:3328 nt
L_rest10:
    buffer_load_dwordx4 v[176:179], v2, s[48:51], s96 offen offset:0 nt
    buffer_load_dwordx4 v[180:183], v2, s[48:51], s96 offen offset:128 nt
    buffer_load_dwordx4 v[184:187], v2, s[48:51], s96 offen offset:256 nt
L_rest11:
    buffer_load_dwordx4 v[188:191], v2, s[48:51], s96 offen offset:3072 nt
    buffer_load_dwordx4 v[192:195], v2, s[48:51], s96 offen offset:3200 nt
    buffer_load_dwordx4 v[196:199], v2, s[48:51], s96 offen offset:3328 nt
L_join:
    s_nop 4
    v_and_b32 v5, 7, v1
    v_lshlrev_b32 v5, 4, v5
    ds_read_b128 v[20:23], v5 offset:7680
    ds_read_b128 v[24:27], v5 offset:7808
    ds_read_b128 v[28:31], v5 offset:7936
    v_mov_b32 v32, 0
    v_mov_b32 v33, 0
    v_mov_b32 v34, 0
    v_mov_b32 v35, 0
    v_mov_b32 v36, 0
    v_mov_b32 v37, 0
    v_mov_b32 v38, 0
    v_mov_b32 v39, 0
    v_mov_b32 v40, 0
    v_mov_b32 v41, 0
    v_mov_b32 v42, 0
    v_mov_b32 v43, 0
    v_mov_b32 v44, 0
    v_mov_b32 v45, 0
    v_mov_b32 v46, 0
    v_mov_b32 v47, 0
    v_mov_b32 v48, 0
    v_mov_b32 v49, 0
    v_mov_b32 v50, 0
    v_mov_b32 v51, 0
    v_mov_b32 v52, 0
    v_mov_b32 v53, 0
    v_mov_b32 v54, 0
    v_mov_b32 v55, 0
    v_mov_b32 v200, 0xff7fffff
    v_mov_b32 v201, 0
    s_add_u32 s8, s7, 168
    s_waitcnt lgkmcnt(0)
    s_and_b32 s9, s8, 511
    s_mul_i32 s9, s9, 6144
    s_bfe_u32 s10, s8, 0x10009
    s_mul_i32 s10, s10, 100663296
    s_add_u32 s76, s78, s9
    s_add_u32 s76, s76, s10
    s_cmp_lt_u32 s8, 1024
    s_cselect_b32 s46, 0xc000000, 0
    s_mov_b32 s50, s46
    s_waitcnt vmcnt(33)
    v_mov_b32 v5, 0
    v_mov_b32 v6, 0
    v_mov_b32 v7, 0
    v_dot2c_f32_bf16 v5, v56, v20
    v_dot2c_f32_bf16 v6, v60, v24
    v_dot2c_f32_bf16 v7, v64, v28
    v_dot2c_f32_bf16 v5, v57, v21
    v_dot2c_f32_bf16 v6, v61, v25
    v_dot2c_f32_bf16 v7, v65, v29
    v_dot2c_f32_bf16 v5, v58, v22
    v_dot2c_f32_bf16 v6, v62, v26
    v_dot2c_f32_bf16 v7, v66, v30
    v_dot2c_f32_bf16 v5, v59, v23
    v_dot2c_f32_bf16 v6, v63, v27
    v_dot2c_f32_bf16 v7, v67, v31
    buffer_load_dwordx4 v[56:59], v2, s[44:47], s76 offen offset:0 nt
    buffer_load_dwordx4 v[60:63], v2, s[44:47], s76 offen offset:128 nt
    buffer_load_dwordx4 v[64:67], v2, s[44:47], s76 offen offset:256 nt
    s_waitcnt vmcnt(33)
    v_mov_b32 v8, 0
    v_mov_b32 v9, 0
    v_mov_b32 v10, 0
    v_dot2c_f32_bf16 v8, v68, v20
    v_dot2c_f32_bf16 v9, v72, v24
    v_dot2c_f32_bf16 v10, v76, v28
    v_dot2c_f32_bf16 v8, v69, v21
    v_dot2c_f32_bf16 v9, v73, v25
    v_dot2c_f32_bf16 v10, v77, v29
    v_dot2c_f32_bf16 v8, v70, v22
    v_dot2c_f32_bf16 v9, v74, v26
    v_dot2c_f32_bf16 v10, v78, v30
    v_dot2c_f32_bf16 v8, v71, v23
    v_dot2c_f32_bf16 v9, v75, v27
    v_dot2c_f32_bf16 v10, v79, v31
    buffer_load_dwordx4 v[68:71], v2, s[44:47], s76 offen offset:3072 nt
    buffer_load_dwordx4 v[72:75], v2, s[44:47], s76 offen offset:3200 nt
    buffer_load_dwordx4 v[76:79], v2, s[44:47], s76 offen offset:3328 nt
    v_add_f32 v5, v5, v6
    v_add_f32 v8, v8, v9
    v_add_f32 v16, v5, v7
    v_add_f32 v17, v8, v10
    s_nop 0
    v_add_f32_dpp v16, v16, v16 quad_perm:[1,0,3,2] row_mask:0xf bank_mask:0xf
    v_add_f32_dpp v17, v17, v17 quad_perm:[1,0,3,2] row_mask:0xf bank_mask:0xf
    s_nop 0
    v_add_f32_dpp v16, v16, v16 quad_perm:[2,3,0,1] row_mask:0xf bank_mask:0xf
    v_add_f32_dpp v17, v17, v17 quad_perm:[2,3,0,1] row_mask:0xf bank_mask:0xf
    s_nop 0
    v_add_f32_dpp v16, v16, v16 row_half_mirror row_mask:0xf bank_mask:0xf
    v_add_f32_dpp v17, v17, v17 row_half_mirror row_mask:0xf bank_mask:0xf
    v_cvt_pk_bf16_f32 v5, v16, v17
    v_lshlrev_b32 v16, 16, v5
    v_and_b32 v17, s14, v5
    v_mul_f32 v16, 0x3d93cd3a, v16
    v_mul_f32 v17, 0x3d93cd3a, v17
    v_cvt_pk_bf16_f32 v5, v16, v17
    v_lshlrev_b32 v16, 16, v5
    v_and_b32 v17, s14, v5
    v_max3_f32 v7, v200, v16, v17
    v_sub_f32 v202, v200, v7
    v_sub_f32 v16, v16, v7
    v_sub_f32 v17, v17, v7
    v_mov_b32 v200, v7
    v_mul_f32 v202, 0x3fb8aa3b, v202
    v_mul_f32 v16, 0x3fb8aa3b, v16
    v_mul_f32 v17, 0x3fb8aa3b, v17
    v_exp_f32 v202, v202
    v_exp_f32 v16, v16
    v_exp_f32 v17, v17
    s_nop 0
    v_add_f32 v5, v16, v17
    v_fma_f32 v201, v201, v202, v5
    v_pk_mul_f32 v[32:33], v[32:33], v[202:203] op_sel_hi:[1,0]
    v_pk_mul_f32 v[34:35], v[34:35], v[202:203] op_sel_hi:[1,0]
    v_pk_mul_f32 v[36:37], v[36:37], v[202:203] op_sel_hi:[1,0]
    v_pk_mul_f32 v[38:39], v[38:39], v[202:203] op_sel_hi:[1,0]
    v_pk_mul_f32 v[40:41], v[40:41], v[202:203] op_sel_hi:[1,0]
    v_pk_mul_f32 v[42:43], v[42:43], v[202:203] op_sel_hi:[1,0]
    v_pk_mul_f32 v[44:45], v[44:45], v[202:203] op_sel_hi:[1,0]
    v_pk_mul_f32 v[46:47], v[46:47], v[202:203] op_sel_hi:[1,0]
    v_pk_mul_f32 v[48:49], v[48:49], v[202:203] op_sel_hi:[1,0]
    v_pk_mul_f32 v[50:51], v[50:51], v[202:203] op_sel_hi:[1,0]
    v_pk_mul_f32 v[52:53], v[52:53], v[202:203] op_sel_hi:[1,0]
    v_pk_mul_f32 v[54:55], v[54:55], v[202:203] op_sel_hi:[1,0]
    s_waitcnt vmcnt(33)
    v_lshlrev_b32 v5, 16, v80
    v_and_b32 v6, s14, v80
    v_lshlrev_b32 v7, 16, v81
    v_and_b32 v8, s14, v81
    v_fmac_f32 v32, v16, v5
    v_fmac_f32 v33, v16, v6
    v_fmac_f32 v34, v16, v7
    v_fmac_f32 v35, v16, v8
    v_lshlrev_b32 v9, 16, v82
    v_and_b32 v10, s14, v82
    v_lshlrev_b32 v11, 16, v83
    v_and_b32 v12, s14, v83
    v_fmac_f32 v36, v16, v9
    v_fmac_f32 v37, v16, v10
    v_fmac_f32 v38, v16, v11
    v_fmac_f32 v39, v16, v12
    v_lshlrev_b32 v5, 16, v84
    v_and_b32 v6, s14, v84
    v_lshlrev_b32 v7, 16, v85
    v_and_b32 v8, s14, v85
    v_fmac_f32 v40, v16, v5
    v_fmac_f32 v41, v16, v6
    v_fmac_f32 v42, v16, v7
    v_fmac_f32 v43, v16, v8
    v_lshlrev_b32 v9, 16, v86
    v_and_b32 v10, s14, v86
    v_lshlrev_b32 v11, 16, v87
    v_and_b32 v12, s14, v87
    v_fmac_f32 v44, v16, v9
    v_fmac_f32 v45, v16, v10
    v_fmac_f32 v46, v16, v11
    v_fmac_f32 v47, v16, v12
    v_lshlrev_b32 v5, 16, v88
    v_and_b32 v6, s14, v88
    v_lshlrev_b32 v7, 16, v89
    v_and_b32 v8, s14, v89
    v_fmac_f32 v48, v16, v5
    v_fmac_f32 v49, v16, v6
    v_fmac_f32 v50, v16, v7
    v_fmac_f32 v51, v16, v8
    v_lshlrev_b32 v9, 16, v90
    v_and_b32 v10, s14, v90
    v_lshlrev_b32 v11, 16, v91
    v_and_b32 v12, s14, v91
    v_fmac_f32 v52, v16, v9
    v_fmac_f32 v53, v16, v10
    v_fmac_f32 v54, v16, v11
    v_fmac_f32 v55, v16, v12
    buffer_load_dwordx4 v[80:83], v2, s[48:51], s76 offen offset:0 nt
    buffer_load_dwordx4 v[84:87], v2, s[48:51], s76 offen offset:128 nt
    buffer_load_dwordx4 v[88:91], v2, s[48:51], s76 offen offset:256 nt
    s_waitcnt vmcnt(33)
    v_lshlrev_b32 v5, 16, v92
    v_and_b32 v6, s14, v92
    v_lshlrev_b32 v7, 16, v93
    v_and_b32 v8, s14, v93
    v_fmac_f32 v32, v17, v5
    v_fmac_f32 v33, v17, v6
    v_fmac_f32 v34, v17, v7
    v_fmac_f32 v35, v17, v8
    v_lshlrev_b32 v9, 16, v94
    v_and_b32 v10, s14, v94
    v_lshlrev_b32 v11, 16, v95
    v_and_b32 v12, s14, v95
    v_fmac_f32 v36, v17, v9
    v_fmac_f32 v37, v17, v10
    v_fmac_f32 v38, v17, v11
    v_fmac_f32 v39, v17, v12
    v_lshlrev_b32 v5, 16, v96
    v_and_b32 v6, s14, v96
    v_lshlrev_b32 v7, 16, v97
    v_and_b32 v8, s14, v97
    v_fmac_f32 v40, v17, v5
    v_fmac_f32 v41, v17, v6
    v_fmac_f32 v42, v17, v7
    v_fmac_f32 v43, v17, v8
    v_lshlrev_b32 v9, 16, v98
    v_and_b32 v10, s14, v98
    v_lshlrev_b32 v11, 16, v99
    v_and_b32 v12, s14, v99
    v_fmac_f32 v44, v17, v9
    v_fmac_f32 v45, v17, v10
    v_fmac_f32 v46, v17, v11
    v_fmac_f32 v47, v17, v12
    v_lshlrev_b32 v5, 16, v100
    v_and_b32 v6, s14, v100
    v_lshlrev_b32 v7, 16, v101
    v_and_b32 v8, s14, v101
    v_fmac_f32 v48, v17, v5
    v_fmac_f32 v49, v17, v6
    v_fmac_f32 v50, v17, v7
    v_fmac_f32 v51, v17, v8
    v_lshlrev_b32 v9, 16, v102
    v_and_b32 v10, s14, v102
    v_lshlrev_b32 v11, 16, v103
    v_and_b32 v12, s14, v103
    v_fmac_f32 v52, v17, v9
    v_fmac_f32 v53, v17, v10
    v_fmac_f32 v54, v17, v11
    v_fmac_f32 v55, v17, v12
    buffer_load_dwordx4 v[92:95], v2, s[48:51], s76 offen offset:3072 nt
    buffer_load_dwordx4 v[96:99], v2, s[48:51], s76 offen offset:3200 nt
    buffer_load_dwordx4 v[100:103], v2, s[48:51], s76 offen offset:3328 nt
    s_waitcnt vmcnt(33)
    v_mov_b32 v5, 0
    v_mov_b32 v6, 0
    v_mov_b32 v7, 0
    v_dot2c_f32_bf16 v5, v104, v20
    v_dot2c_f32_bf16 v6, v108, v24
    v_dot2c_f32_bf16 v7, v112, v28
    v_dot2c_f32_bf16 v5, v105, v21
    v_dot2c_f32_bf16 v6, v109, v25
    v_dot2c_f32_bf16 v7, v113, v29
    v_dot2c_f32_bf16 v5, v106, v22
    v_dot2c_f32_bf16 v6, v110, v26
    v_dot2c_f32_bf16 v7, v114, v30
    v_dot2c_f32_bf16 v5, v107, v23
    v_dot2c_f32_bf16 v6, v111, v27
    v_dot2c_f32_bf16 v7, v115, v31
    s_waitcnt vmcnt(30)
    v_mov_b32 v8, 0
    v_mov_b32 v9, 0
    v_mov_b32 v10, 0
    v_dot2c_f32_bf16 v8, v116, v20
    v_dot2c_f32_bf16 v9, v120, v24
    v_dot2c_f32_bf16 v10, v124, v28
    v_dot2c_f32_bf16 v8, v117, v21
    v_dot2c_f32_bf16 v9, v121, v25
    v_dot2c_f32_bf16 v10, v125, v29
    v_dot2c_f32_bf16 v8, v118, v22
    v_dot2c_f32_bf16 v9, v122, v26
    v_dot2c_f32_bf16 v10, v126, v30
    v_dot2c_f32_bf16 v8, v119, v23
    v_dot2c_f32_bf16 v9, v123, v27
    v_dot2c_f32_bf16 v10, v127, v31
    v_add_f32 v5, v5, v6
    s_nop 0
    v_add_f32 v8, v8, v9
    v_add_f32 v16, v5, v7
    v_add_f32 v17, v8, v10
    s_nop 0
    v_add_f32_dpp v16, v16, v16 quad_perm:[1,0,3,2] row_mask:0xf bank_mask:0xf
    v_add_f32_dpp v17, v17, v17 quad_perm:[1,0,3,2] row_mask:0xf bank_mask:0xf
    s_nop 0
    v_add_f32_dpp v16, v16, v16 quad_perm:[2,3,0,1] row_mask:0xf bank_mask:0xf
    v_add_f32_dpp v17, v17, v17 quad_perm:[2,3,0,1] row_mask:0xf bank_mask:0xf
    s_nop 0
    v_add_f32_dpp v16, v16, v16 row_half_mirror row_mask:0xf bank_mask:0xf
    v_add_f32_dpp v17, v17, v17 row_half_mirror row_mask:0xf bank_mask:0xf
    v_cvt_pk_bf16_f32 v5, v16, v17
    v_lshlrev_b32 v16, 16, v5
    v_and_b32 v17, s14, v5
    v_mul_f32 v16, 0x3d93cd3a, v16
    v_mul_f32 v17, 0x3d93cd3a, v17
    v_cvt_pk_bf16_f32 v5, v16, v17
    v_lshlrev_b32 v16, 16, v5
    v_and_b32 v17, s14, v5
    v_max3_f32 v7, v200, v16, v17
    v_sub_f32 v202, v200, v7
    v_sub_f32 v16, v16, v7
    v_sub_f32 v17, v17, v7
    v_mov_b32 v200, v7
    v_mul_f32 v202, 0x3fb8aa3b, v202
    v_mul_f32 v16, 0x3fb8aa3b, v16
    v_mul_f32 v17, 0x3fb8aa3b, v17
    v_exp_f32 v202, v202
    v_exp_f32 v16, v16
    v_exp_f32 v17, v17
    s_nop 0
    v_add_f32 v5, v16, v17
    v_fma_f32 v201, v201, v202, v5
    v_pk_mul_f32 v[32:33], v[32:33], v[202:203] op_sel_hi:[1,0]
    v_pk_mul_f32 v[34:35], v[34:35], v[202:203] op_sel_hi:[1,0]
    v_pk_mul_f32 v[36:37], v[36:37], v[202:203] op_sel_hi:[1,0]
    v_pk_mul_f32 v[38:39], v[38:39], v[202:203] op_sel_hi:[1,0]
    v_pk_mul_f32 v[40:41], v[40:41], v[202:203] op_sel_hi:[1,0]
    v_pk_mul_f32 v[42:43], v[42:43], v[202:203] op_sel_hi:[1,0]
    v_pk_mul_f32 v[44:45], v[44:45], v[202:203] op_sel_hi:[1,0]
    v_pk_mul_f32 v[46:47], v[46:47], v[202:203] op_sel_hi:[1,0]
    v_pk_mul_f32 v[48:49], v[48:49], v[202:203] op_sel_hi:[1,0]
    v_pk_mul_f32 v[50:51], v[50:51], v[202:203] op_sel_hi:[1,0]
    v_pk_mul_f32 v[52:53], v[52:53], v[202:203] op_sel_hi:[1,0]
    v_pk_mul_f32 v[54:55], v[54:55], v[202:203] op_sel_hi:[1,0]
    s_waitcnt vmcnt(27)
    v_lshlrev_b32 v5, 16, v128
    v_and_b32 v6, s14, v128
    v_lshlrev_b32 v7, 16, v129
    v_and_b32 v8, s14, v129
    v_fmac_f32 v32, v16, v5
    v_fmac_f32 v33, v16, v6
    v_fmac_f32 v34, v16, v7
    v_fmac_f32 v35, v16, v8
    v_lshlrev_b32 v9, 16, v130
    v_and_b32 v10, s14, v130
    v_lshlrev_b32 v11, 16, v131
    v_and_b32 v12, s14, v131
    v_fmac_f32 v36, v16, v9
    v_fmac_f32 v37, v16, v10
    v_fmac_f32 v38, v16, v11
    v_fmac_f32 v39, v16, v12
    v_lshlrev_b32 v5, 16, v132
    v_and_b32 v6, s14, v132
    v_lshlrev_b32 v7, 16, v133
    v_and_b32 v8, s14, v133
    v_fmac_f32 v40, v16, v5
    v_fmac_f32 v41, v16, v6
    v_fmac_f32 v42, v16, v7
    v_fmac_f32 v43, v16, v8
    v_lshlrev_b32 v9, 16, v134
    v_and_b32 v10, s14, v134
    v_lshlrev_b32 v11, 16, v135
    v_and_b32 v12, s14, v135
    v_fmac_f32 v44, v16, v9
    v_fmac_f32 v45, v16, v10
    v_fmac_f32 v46, v16, v11
    v_fmac_f32 v47, v16, v12
    v_lshlrev_b32 v5, 16, v136
    v_and_b32 v6, s14, v136
    v_lshlrev_b32 v7, 16, v137
    v_and_b32 v8, s14, v137
    v_fmac_f32 v48, v16, v5
    v_fmac_f32 v49, v16, v6
    v_fmac_f32 v50, v16, v7
    v_fmac_f32 v51, v16, v8
    v_lshlrev_b32 v9, 16, v138
    v_and_b32 v10, s14, v138
    v_lshlrev_b32 v11, 16, v139
    v_and_b32 v12, s14, v139
    v_fmac_f32 v52, v16, v9
    v_fmac_f32 v53, v16, v10
    v_fmac_f32 v54, v16, v11
    v_fmac_f32 v55, v16, v12
    s_waitcnt vmcnt(24)
    v_lshlrev_b32 v5, 16, v140
    v_and_b32 v6, s14, v140
    v_lshlrev_b32 v7, 16, v141
    v_and_b32 v8, s14, v141
    v_fmac_f32 v32, v17, v5
    v_fmac_f32 v33, v17, v6
    v_fmac_f32 v34, v17, v7
    v_fmac_f32 v35, v17, v8
    v_lshlrev_b32 v9, 16, v142
    v_and_b32 v10, s14, v142
    v_lshlrev_b32 v11, 16, v143
    v_and_b32 v12, s14, v143
    v_fmac_f32 v36, v17, v9
    v_fmac_f32 v37, v17, v10
    v_fmac_f32 v38, v17, v11
    v_fmac_f32 v39, v17, v12
    v_lshlrev_b32 v5, 16, v144
    v_and_b32 v6, s14, v144
    v_lshlrev_b32 v7, 16, v145
    v_and_b32 v8, s14, v145
    v_fmac_f32 v40, v17, v5
    v_fmac_f32 v41, v17, v6
    v_fmac_f32 v42, v17, v7
    v_fmac_f32 v43, v17, v8
    v_lshlrev_b32 v9, 16, v146
    v_and_b32 v10, s14, v146
    v_lshlrev_b32 v11, 16, v147
    v_and_b32 v12, s14, v147
    v_fmac_f32 v44, v17, v9
    v_fmac_f32 v45, v17, v10
    v_fmac_f32 v46, v17, v11
    v_fmac_f32 v47, v17, v12
    v_lshlrev_b32 v5, 16, v148
    v_and_b32 v6, s14, v148
    v_lshlrev_b32 v7, 16, v149
    v_and_b32 v8, s14, v149
    v_fmac_f32 v48, v17, v5
    v_fmac_f32 v49, v17, v6
    v_fmac_f32 v50, v17, v7
    v_fmac_f32 v51, v17, v8
    v_lshlrev_b32 v9, 16, v150
    v_and_b32 v10, s14, v150
    v_lshlrev_b32 v11, 16, v151
    v_and_b32 v12, s14, v151
    v_fmac_f32 v52, v17, v9
    v_fmac_f32 v53, v17, v10
    v_fmac_f32 v54, v17, v11
    v_fmac_f32 v55, v17, v12
    s_waitcnt vmcnt(21)
    v_mov_b32 v5, 0
    v_mov_b32 v6, 0
    v_mov_b32 v7, 0
    v_dot2c_f32_bf16 v5, v152, v20
    v_dot2c_f32_bf16 v6, v156, v24
    v_dot2c_f32_bf16 v7, v160, v28
    v_dot2c_f32_bf16 v5, v153, v21
    v_dot2c_f32_bf16 v6, v157, v25
    v_dot2c_f32_bf16 v7, v161, v29
    v_dot2c_f32_bf16 v5, v154, v22
    v_dot2c_f32_bf16 v6, v158, v26
    v_dot2c_f32_bf16 v7, v162, v30
    v_dot2c_f32_bf16 v5, v155, v23
    v_dot2c_f32_bf16 v6, v159, v27
    v_dot2c_f32_bf16 v7, v163, v31
    s_waitcnt vmcnt(18)
    v_mov_b32 v8, 0
    v_mov_b32 v9, 0
    v_mov_b32 v10, 0
    v_dot2c_f32_bf16 v8, v164, v20
    v_dot2c_f32_bf16 v9, v168, v24
    v_dot2c_f32_bf16 v10, v172, v28
    v_dot2c_f32_bf16 v8, v165, v21
    v_dot2c_f32_bf16 v9, v169, v25
    v_dot2c_f32_bf16 v10, v173, v29
    v_dot2c_f32_bf16 v8, v166, v22
    v_dot2c_f32_bf16 v9, v170, v26
    v_dot2c_f32_bf16 v10, v174, v30
    v_dot2c_f32_bf16 v8, v167, v23
    v_dot2c_f32_bf16 v9, v171, v27
    v_dot2c_f32_bf16 v10, v175, v31
    v_add_f32 v5, v5, v6
    s_nop 0
    v_add_f32 v8, v8, v9
    v_add_f32 v16, v5, v7
    v_add_f32 v17, v8, v10
    s_nop 0
    v_add_f32_dpp v16, v16, v16 quad_perm:[1,0,3,2] row_mask:0xf bank_mask:0xf
    v_add_f32_dpp v17, v17, v17 quad_perm:[1,0,3,2] row_mask:0xf bank_mask:0xf
    s_nop 0
    v_add_f32_dpp v16, v16, v16 quad_perm:[2,3,0,1] row_mask:0xf bank_mask:0xf
    v_add_f32_dpp v17, v17, v17 quad_perm:[2,3,0,1] row_mask:0xf bank_mask:0xf
    s_nop 0
    v_add_f32_dpp v16, v16, v16 row_half_mirror row_mask:0xf bank_mask:0xf
    v_add_f32_dpp v17, v17, v17 row_half_mirror row_mask:0xf bank_mask:0xf
    v_cvt_pk_bf16_f32 v5, v16, v17
    v_lshlrev_b32 v16, 16, v5
    v_and_b32 v17, s14, v5
    v_mul_f32 v16, 0x3d93cd3a, v16
    v_mul_f32 v17, 0x3d93cd3a, v17
    v_cvt_pk_bf16_f32 v5, v16, v17
    v_lshlrev_b32 v16, 16, v5
    v_and_b32 v17, s14, v5
    v_max3_f32 v7, v200, v16, v17
    v_sub_f32 v202, v200, v7
    v_sub_f32 v16, v16, v7
    v_sub_f32 v17, v17, v7
    v_mov_b32 v200, v7
    v_mul_f32 v202, 0x3fb8aa3b, v202
    v_mul_f32 v16, 0x3fb8aa3b, v16
    v_mul_f32 v17, 0x3fb8aa3b, v17
    v_exp_f32 v202, v202
    v_exp_f32 v16, v16
    v_exp_f32 v17, v17
    s_nop 0
    v_add_f32 v5, v16, v17
    v_fma_f32 v201, v201, v202, v5
    v_pk_mul_f32 v[32:33], v[32:33], v[202:203] op_sel_hi:[1,0]
    v_pk_mul_f32 v[34:35], v[34:35], v[202:203] op_sel_hi:[1,0]
    v_pk_mul_f32 v[36:37], v[36:37], v[202:203] op_sel_hi:[1,0]
    v_pk_mul_f32 v[38:39], v[38:39], v[202:203] op_sel_hi:[1,0]
    v_pk_mul_f32 v[40:41], v[40:41], v[202:203] op_sel_hi:[1,0]
    v_pk_mul_f32 v[42:43], v[42:43], v[202:203] op_sel_hi:[1,0]
    v_pk_mul_f32 v[44:45], v[44:45], v[202:203] op_sel_hi:[1,0]
    v_pk_mul_f32 v[46:47], v[46:47], v[202:203] op_sel_hi:[1,0]
    v_pk_mul_f32 v[48:49], v[48:49], v[202:203] op_sel_hi:[1,0]
    v_pk_mul_f32 v[50:51], v[50:51], v[202:203] op_sel_hi:[1,0]
    v_pk_mul_f32 v[52:53], v[52:53], v[202:203] op_sel_hi:[1,0]
    v_pk_mul_f32 v[54:55], v[54:55], v[202:203] op_sel_hi:[1,0]
    s_waitcnt vmcnt(15)
    v_lshlrev_b32 v5, 16, v176
    v_and_b32 v6, s14, v176
    v_lshlrev_b32 v7, 16, v177
    v_and_b32 v8, s14, v177
    v_fmac_f32 v32, v16, v5
    v_fmac_f32 v33, v16, v6
    v_fmac_f32 v34, v16, v7
    v_fmac_f32 v35, v16, v8
    v_lshlrev_b32 v9, 16, v178
    v_and_b32 v10, s14, v178
    v_lshlrev_b32 v11, 16, v179
    v_and_b32 v12, s14, v179
    v_fmac_f32 v36, v16, v9
    v_fmac_f32 v37, v16, v10
    v_fmac_f32 v38, v16, v11
    v_fmac_f32 v39, v16, v12
    v_lshlrev_b32 v5, 16, v180
    v_and_b32 v6, s14, v180
    v_lshlrev_b32 v7, 16, v181
    v_and_b32 v8, s14, v181
    v_fmac_f32 v40, v16, v5
    v_fmac_f32 v41, v16, v6
    v_fmac_f32 v42, v16, v7
    v_fmac_f32 v43, v16, v8
    v_lshlrev_b32 v9, 16, v182
    v_and_b32 v10, s14, v182
    v_lshlrev_b32 v11, 16, v183
    v_and_b32 v12, s14, v183
    v_fmac_f32 v44, v16, v9
    v_fmac_f32 v45, v16, v10
    v_fmac_f32 v46, v16, v11
    v_fmac_f32 v47, v16, v12
    v_lshlrev_b32 v5, 16, v184
    v_and_b32 v6, s14, v184
    v_lshlrev_b32 v7, 16, v185
    v_and_b32 v8, s14, v185
    v_fmac_f32 v48, v16, v5
    v_fmac_f32 v49, v16, v6
    v_fmac_f32 v50, v16, v7
    v_fmac_f32 v51, v16, v8
    v_lshlrev_b32 v9, 16, v186
    v_and_b32 v10, s14, v186
    v_lshlrev_b32 v11, 16, v187
    v_and_b32 v12, s14, v187
    v_fmac_f32 v52, v16, v9
    v_fmac_f32 v53, v16, v10
    v_fmac_f32 v54, v16, v11
    v_fmac_f32 v55, v16, v12
    s_waitcnt vmcnt(12)
    v_lshlrev_b32 v5, 16, v188
    v_and_b32 v6, s14, v188
    v_lshlrev_b32 v7, 16, v189
    v_and_b32 v8, s14, v189
    v_fmac_f32 v32, v17, v5
    v_fmac_f32 v33, v17, v6
    v_fmac_f32 v34, v17, v7
    v_fmac_f32 v35, v17, v8
    v_lshlrev_b32 v9, 16, v190
    v_and_b32 v10, s14, v190
    v_lshlrev_b32 v11, 16, v191
    v_and_b32 v12, s14, v191
    v_fmac_f32 v36, v17, v9
    v_fmac_f32 v37, v17, v10
    v_fmac_f32 v38, v17, v11
    v_fmac_f32 v39, v17, v12
    v_lshlrev_b32 v5, 16, v192
    v_and_b32 v6, s14, v192
    v_lshlrev_b32 v7, 16, v193
    v_and_b32 v8, s14, v193
    v_fmac_f32 v40, v17, v5
    v_fmac_f32 v41, v17, v6
    v_fmac_f32 v42, v17, v7
    v_fmac_f32 v43, v17, v8
    v_lshlrev_b32 v9, 16, v194
    v_and_b32 v10, s14, v194
    v_lshlrev_b32 v11, 16, v195
    v_and_b32 v12, s14, v195
    v_fmac_f32 v44, v17, v9
    v_fmac_f32 v45, v17, v10
    v_fmac_f32 v46, v17, v11
    v_fmac_f32 v47, v17, v12
    v_lshlrev_b32 v5, 16, v196
    v_and_b32 v6, s14, v196
    v_lshlrev_b32 v7, 16, v197
    v_and_b32 v8, s14, v197
    v_fmac_f32 v48, v17, v5
    v_fmac_f32 v49, v17, v6
    v_fmac_f32 v50, v17, v7
    v_fmac_f32 v51, v17, v8
    v_lshlrev_b32 v9, 16, v198
    v_and_b32 v10, s14, v198
    v_lshlrev_b32 v11, 16, v199
    v_and_b32 v12, s14, v199
    v_fmac_f32 v52, v17, v9
    v_fmac_f32 v53, v17, v10
    v_fmac_f32 v54, v17, v11
    v_fmac_f32 v55, v17, v12
    s_mov_b32 s7, s8
    s_mov_b32 s101, s100
    s_branch L_pf
L_join7:
    s_setprio 0
    v_mov_b32 v205, v242
    v_mov_b32 v32, 0
    v_mov_b32 v33, 0
    v_mov_b32 v34, 0
    v_mov_b32 v35, 0
    v_mov_b32 v36, 0
    v_mov_b32 v37, 0
    v_mov_b32 v38, 0
    v_mov_b32 v39, 0
    v_mov_b32 v40, 0
    v_mov_b32 v41, 0
    v_mov_b32 v42, 0
    v_mov_b32 v43, 0
    v_mov_b32 v44, 0
    v_mov_b32 v45, 0
    v_mov_b32 v46, 0
    v_mov_b32 v47, 0
    v_mov_b32 v48, 0
    v_mov_b32 v49, 0
    v_mov_b32 v50, 0
    v_mov_b32 v51, 0
    v_mov_b32 v52, 0
    v_mov_b32 v53, 0
    v_mov_b32 v54, 0
    v_mov_b32 v55, 0
    v_mov_b32 v200, 0xff7fffff
    v_mov_b32 v201, 0
L_pf:
    s_nop 4
    s_mov_b32 s64, s24
    s_mov_b32 s65, s25
    s_mov_b32 s66, 0x780000
    s_mov_b32 s67, 0x20000
    s_mov_b32 s68, s38
    s_mov_b32 s69, s39
    s_mov_b32 s70, 0x80
    s_mov_b32 s71, 0x20000
    v_mov_b32 v206, 0
    v_lshlrev_b32 v7, 1, v0
    s_mov_b32 s72, s28
    s_mov_b32 s73, s29
    s_mov_b32 s74, 0xc00
    s_mov_b32 s75, 0x20000
    buffer_load_ushort v232, v7, s[72:75], 0 offen offset:0
    buffer_load_ushort v233, v7, s[72:75], 0 offen offset:1024
    buffer_load_ushort v234, v7, s[72:75], 0 offen offset:2048
    s_mov_b32 s72, s30
    s_mov_b32 s73, s31
    s_mov_b32 s74, 0xc00
    s_mov_b32 s75, 0x20000
    buffer_load_ushort v235, v7, s[72:75], 0 offen offset:0
    buffer_load_ushort v236, v7, s[72:75], 0 offen offset:1024
    buffer_load_ushort v237, v7, s[72:75], 0 offen offset:2048
    s_mov_b32 s72, s32
    s_mov_b32 s73, s33
    s_mov_b32 s74, 0xc00
    s_mov_b32 s75, 0x20000
    buffer_load_ushort v238, v7, s[72:75], 0 offen offset:0
    buffer_load_ushort v239, v7, s[72:75], 0 offen offset:1024
    buffer_load_ushort v240, v7, s[72:75], 0 offen offset:2048
    s_mov_b32 s72, s34
    s_mov_b32 s73, s35
    s_mov_b32 s74, 0x2
    s_mov_b32 s75, 0x20000
    buffer_load_ushort v241, off, s[72:75], 0
    v_lshlrev_b32 v7, 3, v0
    s_lshr_b32 s9, s2, 7
    s_mul_i32 s9, s9, 1280
    s_mov_b32 s72, s16
    s_mov_b32 s73, s17
    s_mov_b32 s74, 0xa00
    s_mov_b32 s75, 0x20000
    buffer_load_dwordx2 v[242:243], v7, s[72:75], s9 offen
.p2align 3
L_loop:
    s_lshr_b32 s9, s7, 9
    s_cmp_lg_u32 s9, s6
    s_cbranch_scc1 L_flush
    s_mov_b32 s8, 0x7fffffff
    s_cmp_ge_u32 s3, 5
    s_cbranch_scc1 L_gotql
    s_mov_b64 exec, 1
    ds_add_rtn_u32 v204, v18, v19 offset:20872
    s_mov_b64 exec, -1
    s_mov_b32 s94, 262144
    s_waitcnt lgkmcnt(0)
    v_readfirstlane_b32 s9, v204
    s_nop 0
    s_lshl_b32 s9, s9, 2
    v_mov_b32 v204, s9
L_spinql:
    ds_read_b32 v205, v204 offset:20896
    s_waitcnt lgkmcnt(0)
    v_readfirstlane_b32 s8, v205
    s_nop 0
    s_cmp_lg_u32 s8, -1
    s_cbranch_scc1 L_gotql
    s_sleep 1
    s_sub_u32 s94, s94, 1
    s_cmp_lg_u32 s94, 0
    s_cbranch_scc1 L_spinql
    s_mov_b32 s8, 0x7fffffff
L_gotql:
    s_and_b32 s9, s8, 511
    s_mul_i32 s9, s9, 6144
    s_bfe_u32 s10, s8, 0x10009
    s_mul_i32 s10, s10, 100663296
    s_add_u32 s76, s78, s9
    s_add_u32 s76, s76, s10
    s_cmp_lt_u32 s8, 1024
    s_cselect_b32 s46, 0xc000000, 0
    s_mov_b32 s50, s46
    s_waitcnt vmcnt(9)
    v_mov_b32 v5, 0
    v_mov_b32 v6, 0
    v_mov_b32 v7, 0
    v_dot2c_f32_bf16 v5, v56, v20
    v_dot2c_f32_bf16 v6, v60, v24
    v_dot2c_f32_bf16 v7, v64, v28
    v_dot2c_f32_bf16 v5, v57, v21
    v_dot2c_f32_bf16 v6, v61, v25
    v_dot2c_f32_bf16 v7, v65, v29
    v_dot2c_f32_bf16 v5, v58, v22
    v_dot2c_f32_bf16 v6, v62, v26
    v_dot2c_f32_bf16 v7, v66, v30
    v_dot2c_f32_bf16 v5, v59, v23
    v_dot2c_f32_bf16 v6, v63, v27
    v_dot2c_f32_bf16 v7, v67, v31
    buffer_load_dwordx4 v[56:59], v2, s[44:47], s76 offen offset:0 nt
    buffer_load_dwordx4 v[60:63], v2, s[44:47], s76 offen offset:128 nt
    buffer_load_dwordx4 v[64:67], v2, s[44:47], s76 offen offset:256 nt
    s_waitcnt vmcnt(9)
    v_mov_b32 v8, 0
    v_mov_b32 v9, 0
    v_mov_b32 v10, 0
    v_dot2c_f32_bf16 v8, v68, v20
    v_dot2c_f32_bf16 v9, v72, v24
    v_dot2c_f32_bf16 v10, v76, v28
    v_dot2c_f32_bf16 v8, v69, v21
    v_dot2c_f32_bf16 v9, v73, v25
    v_dot2c_f32_bf16 v10, v77, v29
    v_dot2c_f32_bf16 v8, v70, v22
    v_dot2c_f32_bf16 v9, v74, v26
    v_dot2c_f32_bf16 v10, v78, v30
    v_dot2c_f32_bf16 v8, v71, v23
    v_dot2c_f32_bf16 v9, v75, v27
    v_dot2c_f32_bf16 v10, v79, v31
    buffer_load_dwordx4 v[68:71], v2, s[44:47], s76 offen offset:3072 nt
    buffer_load_dwordx4 v[72:75], v2, s[44:47], s76 offen offset:3200 nt
    buffer_load_dwordx4 v[76:79], v2, s[44:47], s76 offen offset:3328 nt
    v_add_f32 v5, v5, v6
    v_add_f32 v8, v8, v9
    v_add_f32 v16, v5, v7
    v_add_f32 v17, v8, v10
    s_nop 0
    v_add_f32_dpp v16, v16, v16 quad_perm:[1,0,3,2] row_mask:0xf bank_mask:0xf
    v_add_f32_dpp v17, v17, v17 quad_perm:[1,0,3,2] row_mask:0xf bank_mask:0xf
    s_nop 0
    v_add_f32_dpp v16, v16, v16 quad_perm:[2,3,0,1] row_mask:0xf bank_mask:0xf
    v_add_f32_dpp v17, v17, v17 quad_perm:[2,3,0,1] row_mask:0xf bank_mask:0xf
    s_nop 0
    v_add_f32_dpp v16, v16, v16 row_half_mirror row_mask:0xf bank_mask:0xf
    v_add_f32_dpp v17, v17, v17 row_half_mirror row_mask:0xf bank_mask:0xf
    v_cvt_pk_bf16_f32 v5, v16, v17
    v_lshlrev_b32 v16, 16, v5
    v_and_b32 v17, s14, v5
    v_mul_f32 v16, 0x3d93cd3a, v16
    v_mul_f32 v17, 0x3d93cd3a, v17
    v_cvt_pk_bf16_f32 v5, v16, v17
    v_lshlrev_b32 v16, 16, v5
    v_and_b32 v17, s14, v5
    v_max3_f32 v7, v200, v16, v17
    v_sub_f32 v202, v200, v7
    v_sub_f32 v16, v16, v7
    v_sub_f32 v17, v17, v7
    v_mov_b32 v200, v7
    v_mul_f32 v202, 0x3fb8aa3b, v202
    v_mul_f32 v16, 0x3fb8aa3b, v16
    v_mul_f32 v17, 0x3fb8aa3b, v17
    v_exp_f32 v202, v202
    v_exp_f32 v16, v16
    v_exp_f32 v17, v17
    s_nop 0
    v_add_f32 v5, v16, v17
    v_fma_f32 v201, v201, v202, v5
    v_pk_mul_f32 v[32:33], v[32:33], v[202:203] op_sel_hi:[1,0]
    v_pk_mul_f32 v[34:35], v[34:35], v[202:203] op_sel_hi:[1,0]
    v_pk_mul_f32 v[36:37], v[36:37], v[202:203] op_sel_hi:[1,0]
    v_pk_mul_f32 v[38:39], v[38:39], v[202:203] op_sel_hi:[1,0]
    v_pk_mul_f32 v[40:41], v[40:41], v[202:203] op_sel_hi:[1,0]
    v_pk_mul_f32 v[42:43], v[42:43], v[202:203] op_sel_hi:[1,0]
    v_pk_mul_f32 v[44:45], v[44:45], v[202:203] op_sel_hi:[1,0]
    v_pk_mul_f32 v[46:47], v[46:47], v[202:203] op_sel_hi:[1,0]
    v_pk_mul_f32 v[48:49], v[48:49], v[202:203] op_sel_hi:[1,0]
    v_pk_mul_f32 v[50:51], v[50:51], v[202:203] op_sel_hi:[1,0]
    v_pk_mul_f32 v[52:53], v[52:53], v[202:203] op_sel_hi:[1,0]
    v_pk_mul_f32 v[54:55], v[54:55], v[202:203] op_sel_hi:[1,0]
    s_waitcnt vmcnt(9)
    v_lshlrev_b32 v5, 16, v80
    v_and_b32 v6, s14, v80
    v_lshlrev_b32 v7, 16, v81
    v_and_b32 v8, s14, v81
    v_fmac_f32 v32, v16, v5
    v_fmac_f32 v33, v16, v6
    v_fmac_f32 v34, v16, v7
    v_fmac_f32 v35, v16, v8
    v_lshlrev_b32 v9, 16, v82
    v_and_b32 v10, s14, v82
    v_lshlrev_b32 v11, 16, v83
    v_and_b32 v12, s14, v83
    v_fmac_f32 v36, v16, v9
    v_fmac_f32 v37, v16, v10
    v_fmac_f32 v38, v16, v11
    v_fmac_f32 v39, v16, v12
    v_lshlrev_b32 v5, 16, v84
    v_and_b32 v6, s14, v84
    v_lshlrev_b32 v7, 16, v85
    v_and_b32 v8, s14, v85
    v_fmac_f32 v40, v16, v5
    v_fmac_f32 v41, v16, v6
    v_fmac_f32 v42, v16, v7
    v_fmac_f32 v43, v16, v8
    v_lshlrev_b32 v9, 16, v86
    v_and_b32 v10, s14, v86
    v_lshlrev_b32 v11, 16, v87
    v_and_b32 v12, s14, v87
    v_fmac_f32 v44, v16, v9
    v_fmac_f32 v45, v16, v10
    v_fmac_f32 v46, v16, v11
    v_fmac_f32 v47, v16, v12
    v_lshlrev_b32 v5, 16, v88
    v_and_b32 v6, s14, v88
    v_lshlrev_b32 v7, 16, v89
    v_and_b32 v8, s14, v89
    v_fmac_f32 v48, v16, v5
    v_fmac_f32 v49, v16, v6
    v_fmac_f32 v50, v16, v7
    v_fmac_f32 v51, v16, v8
    v_lshlrev_b32 v9, 16, v90
    v_and_b32 v10, s14, v90
    v_lshlrev_b32 v11, 16, v91
    v_and_b32 v12, s14, v91
    v_fmac_f32 v52, v16, v9
    v_fmac_f32 v53, v16, v10
    v_fmac_f32 v54, v16, v11
    v_fmac_f32 v55, v16, v12
    buffer_load_dwordx4 v[80:83], v2, s[48:51], s76 offen offset:0 nt
    buffer_load_dwordx4 v[84:87], v2, s[48:51], s76 offen offset:128 nt
    buffer_load_dwordx4 v[88:91], v2, s[48:51], s76 offen offset:256 nt
    s_waitcnt vmcnt(9)
    v_lshlrev_b32 v5, 16, v92
    v_and_b32 v6, s14, v92
    v_lshlrev_b32 v7, 16, v93
    v_and_b32 v8, s14, v93
    v_fmac_f32 v32, v17, v5
    v_fmac_f32 v33, v17, v6
    v_fmac_f32 v34, v17, v7
    v_fmac_f32 v35, v17, v8
    v_lshlrev_b32 v9, 16, v94
    v_and_b32 v10, s14, v94
    v_lshlrev_b32 v11, 16, v95
    v_and_b32 v12, s14, v95
    v_fmac_f32 v36, v17, v9
    v_fmac_f32 v37, v17, v10
    v_fmac_f32 v38, v17, v11
    v_fmac_f32 v39, v17, v12
    v_lshlrev_b32 v5, 16, v96
    v_and_b32 v6, s14, v96
    v_lshlrev_b32 v7, 16, v97
    v_and_b32 v8, s14, v97
    v_fmac_f32 v40, v17, v5
    v_fmac_f32 v41, v17, v6
    v_fmac_f32 v42, v17, v7
    v_fmac_f32 v43, v17, v8
    v_lshlrev_b32 v9, 16, v98
    v_and_b32 v10, s14, v98
    v_lshlrev_b32 v11, 16, v99
    v_and_b32 v12, s14, v99
    v_fmac_f32 v44, v17, v9
    v_fmac_f32 v45, v17, v10
    v_fmac_f32 v46, v17, v11
    v_fmac_f32 v47, v17, v12
    v_lshlrev_b32 v5, 16, v100
    v_and_b32 v6, s14, v100
    v_lshlrev_b32 v7, 16, v101
    v_and_b32 v8, s14, v101
    v_fmac_f32 v48, v17, v5
    v_fmac_f32 v49, v17, v6
    v_fmac_f32 v50, v17, v7
    v_fmac_f32 v51, v17, v8
    v_lshlrev_b32 v9, 16, v102
    v_and_b32 v10, s14, v102
    v_lshlrev_b32 v11, 16, v103
    v_and_b32 v12, s14, v103
    v_fmac_f32 v52, v17, v9
    v_fmac_f32 v53, v17, v10
    v_fmac_f32 v54, v17, v11
    v_fmac_f32 v55, v17, v12
    buffer_load_dwordx4 v[92:95], v2, s[48:51], s76 offen offset:3072 nt
    buffer_load_dwordx4 v[96:99], v2, s[48:51], s76 offen offset:3200 nt
    buffer_load_dwordx4 v[100:103], v2, s[48:51], s76 offen offset:3328 nt
    s_mov_b32 s7, s8
    s_mov_b32 s101, s100
    s_branch L_loop
L_flush:
    s_nop 4
    v_max_f32_dpp v8, v200, v200 row_ror:8 row_mask:0xf bank_mask:0xf
    v_mov_b32 v5, v8
    s_nop 1
    v_permlane16_swap_b32 v8, v5
    v_max_f32 v8, v8, v5
    v_mov_b32 v5, v8
    s_nop 1
    v_permlane32_swap_b32 v8, v5
    v_max_f32 v8, v8, v5
    v_sub_f32 v202, v200, v8
    v_mul_f32 v202, 0x3fb8aa3b, v202
    v_exp_f32 v202, v202
    s_nop 0
    v_mul_f32 v9, v201, v202
    v_pk_mul_f32 v[32:33], v[32:33], v[202:203] op_sel_hi:[1,0]
    v_pk_mul_f32 v[34:35], v[34:35], v[202:203] op_sel_hi:[1,0]
    v_pk_mul_f32 v[36:37], v[36:37], v[202:203] op_sel_hi:[1,0]
    v_pk_mul_f32 v[38:39], v[38:39], v[202:203] op_sel_hi:[1,0]
    v_pk_mul_f32 v[40:41], v[40:41], v[202:203] op_sel_hi:[1,0]
    v_pk_mul_f32 v[42:43], v[42:43], v[202:203] op_sel_hi:[1,0]
    v_pk_mul_f32 v[44:45], v[44:45], v[202:203] op_sel_hi:[1,0]
    v_pk_mul_f32 v[46:47], v[46:47], v[202:203] op_sel_hi:[1,0]
    v_pk_mul_f32 v[48:49], v[48:49], v[202:203] op_sel_hi:[1,0]
    v_pk_mul_f32 v[50:51], v[50:51], v[202:203] op_sel_hi:[1,0]
    v_pk_mul_f32 v[52:53], v[52:53], v[202:203] op_sel_hi:[1,0]
    v_pk_mul_f32 v[54:55], v[54:55], v[202:203] op_sel_hi:[1,0]
    v_add_f32_dpp v9, v9, v9 row_ror:8 row_mask:0xf bank_mask:0xf
    v_mov_b32 v5, v9
    s_nop 1
    v_permlane16_swap_b32 v9, v5
    v_add_f32 v9, v9, v5
    v_mov_b32 v5, v9
    s_nop 1
    v_permlane32_swap_b32 v9, v5
    v_add_f32 v9, v9, v5
    v_permlane32_swap_b32 v32, v36
    v_permlane32_swap_b32 v33, v37
    v_permlane32_swap_b32 v34, v38
    v_permlane32_swap_b32 v35, v39
    v_permlane32_swap_b32 v40, v44
    v_permlane32_swap_b32 v41, v45
    v_permlane32_swap_b32 v42, v46
    v_permlane32_swap_b32 v43, v47
    v_permlane32_swap_b32 v48, v52
    v_permlane32_swap_b32 v49, v53
    v_permlane32_swap_b32 v50, v54
    v_permlane32_swap_b32 v51, v55
    v_add_f32 v32, v32, v36
    v_add_f32 v33, v33, v37
    v_add_f32 v34, v34, v38
    v_add_f32 v35, v35, v39
    v_add_f32 v40, v40, v44
    v_add_f32 v41, v41, v45
    v_add_f32 v42, v42, v46
    v_add_f32 v43, v43, v47
    v_add_f32 v48, v48, v52
    v_add_f32 v49, v49, v53
    v_add_f32 v50, v50, v54
    v_add_f32 v51, v51, v55
    v_permlane16_swap_b32 v32, v34
    v_permlane16_swap_b32 v33, v35
    v_permlane16_swap_b32 v40, v42
    v_permlane16_swap_b32 v41, v43
    v_permlane16_swap_b32 v48, v50
    v_permlane16_swap_b32 v49, v51
    v_add_f32 v32, v32, v34
    v_add_f32 v33, v33, v35
    v_add_f32 v40, v40, v42
    v_add_f32 v41, v41, v43
    v_add_f32 v48, v48, v50
    v_add_f32 v49, v49, v51
    v_add_f32_dpp v5, v32, v32 row_ror:8 row_mask:0xf bank_mask:0x3
    s_nop 1
    v_add_f32_dpp v5, v33, v33 row_ror:8 row_mask:0xf bank_mask:0xc
    v_add_f32_dpp v6, v40, v40 row_ror:8 row_mask:0xf bank_mask:0x3
    s_nop 1
    v_add_f32_dpp v6, v41, v41 row_ror:8 row_mask:0xf bank_mask:0xc
    v_add_f32_dpp v7, v48, v48 row_ror:8 row_mask:0xf bank_mask:0x3
    s_nop 1
    v_add_f32_dpp v7, v49, v49 row_ror:8 row_mask:0xf bank_mask:0xc
    s_lshl_b32 s9, s6, 3
    s_add_u32 s9, s9, s3
    s_mul_i32 s10, s9, 768
    v_add_u32 v10, s10, v4
    ds_write_b32 v10, v5 offset:8448
    ds_write_b32 v10, v6 offset:8704
    ds_write_b32 v10, v7 offset:8960
    s_lshl_b32 s9, s9, 3
    v_mov_b32 v11, s9
    ds_write_b64 v11, v[8:9] offset:20736
    s_cmp_lg_u32 s6, 0
    s_cbranch_scc1 L_tail
    s_mov_b32 s6, 1
    v_and_b32 v5, 7, v1
    v_lshlrev_b32 v5, 4, v5
    ds_read_b128 v[20:23], v5 offset:8064
    ds_read_b128 v[24:27], v5 offset:8192
    ds_read_b128 v[28:31], v5 offset:8320
    v_lshlrev_b32 v6, 2, v1
    buffer_load_dword v206, v6, s[68:71], 0 offen sc1
    v_mov_b32 v32, 0
    v_mov_b32 v33, 0
    v_mov_b32 v34, 0
    v_mov_b32 v35, 0
    v_mov_b32 v36, 0
    v_mov_b32 v37, 0
    v_mov_b32 v38, 0
    v_mov_b32 v39, 0
    v_mov_b32 v40, 0
    v_mov_b32 v41, 0
    v_mov_b32 v42, 0
    v_mov_b32 v43, 0
    v_mov_b32 v44, 0
    v_mov_b32 v45, 0
    v_mov_b32 v46, 0
    v_mov_b32 v47, 0
    v_mov_b32 v48, 0
    v_mov_b32 v49, 0
    v_mov_b32 v50, 0
    v_mov_b32 v51, 0
    v_mov_b32 v52, 0
    v_mov_b32 v53, 0
    v_mov_b32 v54, 0
    v_mov_b32 v55, 0
    v_mov_b32 v200, 0xff7fffff
    v_mov_b32 v201, 0
    s_waitcnt lgkmcnt(0)
    s_branch L_loop
L_tail:
    s_nop 4
    s_waitcnt vmcnt(0) lgkmcnt(0)
    s_mov_b32 s94, 262144
    v_lshlrev_b32 v6, 2, v1
L_dbgchk:
    v_cmp_gt_u32 vcc, 8, v206
    s_and_b32 s9, vcc_lo, vcc_lo
    s_cbranch_scc0 L_dbgok
    s_sleep 4
    buffer_load_dword v206, v6, s[68:71], 0 offen sc1
    s_waitcnt vmcnt(0)
    s_sub_u32 s94, s94, 1
    s_cmp_lg_u32 s94, 0
    s_cbranch_scc1 L_dbgchk
L_dbgok:
    v_subrev_u32 v5, 0x100, v0
    v_and_b32 v5, 127, v5
    v_lshlrev_b32 v5, 3, v5
    s_sub_u32 s9, s3, 4
    s_lshr_b32 s9, s9, 1
    s_and_b32 s9, s9, 1
    s_mul_i32 s10, s9, 6144
    v_add_u32 v6, s10, v5
    s_lshl_b32 s10, s9, 6
    v_mov_b32 v7, s10
    s_lshl_b32 s10, s2, 11
    s_lshl_b32 s11, s9, 10
    s_add_u32 s10, s10, s11
    s_add_u32 s10, s10, 1114112
    s_barrier
    s_cmp_lt_u32 s3, 4
    s_cbranch_scc1 L_cmb3
    ds_read_b128 v[56:59], v7 offset:20736
    ds_read_b128 v[60:63], v7 offset:20752
    ds_read_b128 v[64:67], v7 offset:20768
    ds_read_b128 v[68:71], v7 offset:20784
    ds_read_b64 v[32:33], v6 offset:8448
    ds_read_b64 v[34:35], v6 offset:9216
    ds_read_b64 v[36:37], v6 offset:9984
    ds_read_b64 v[38:39], v6 offset:10752
    ds_read_b64 v[40:41], v6 offset:11520
    ds_read_b64 v[42:43], v6 offset:12288
    ds_read_b64 v[44:45], v6 offset:13056
    ds_read_b64 v[46:47], v6 offset:13824
    s_waitcnt lgkmcnt(0)
    v_max3_f32 v8, v56, v58, v60
    v_max3_f32 v8, v8, v62, v64
    v_max3_f32 v8, v8, v66, v68
    v_max_f32 v8, v8, v70
    v_sub_f32 v56, v56, v8
    v_sub_f32 v58, v58, v8
    v_sub_f32 v60, v60, v8
    v_sub_f32 v62, v62, v8
    v_sub_f32 v64, v64, v8
    v_sub_f32 v66, v66, v8
    v_sub_f32 v68, v68, v8
    v_sub_f32 v70, v70, v8
    v_mul_f32 v56, 0x3fb8aa3b, v56
    v_mul_f32 v58, 0x3fb8aa3b, v58
    v_mul_f32 v60, 0x3fb8aa3b, v60
    v_mul_f32 v62, 0x3fb8aa3b, v62
    v_mul_f32 v64, 0x3fb8aa3b, v64
    v_mul_f32 v66, 0x3fb8aa3b, v66
    v_mul_f32 v68, 0x3fb8aa3b, v68
    v_mul_f32 v70, 0x3fb8aa3b, v70
    v_exp_f32 v56, v56
    v_exp_f32 v58, v58
    v_exp_f32 v60, v60
    v_exp_f32 v62, v62
    v_exp_f32 v64, v64
    v_exp_f32 v66, v66
    v_exp_f32 v68, v68
    v_exp_f32 v70, v70
    v_mul_f32 v10, v56, v32
    v_mul_f32 v11, v56, v33
    v_mul_f32 v9, v56, v57
    v_fmac_f32 v10, v58, v34
    v_fmac_f32 v11, v58, v35
    v_fmac_f32 v9, v58, v59
    v_fmac_f32 v10, v60, v36
    v_fmac_f32 v11, v60, v37
    v_fmac_f32 v9, v60, v61
    v_fmac_f32 v10, v62, v38
    v_fmac_f32 v11, v62, v39
    v_fmac_f32 v9, v62, v63
    v_fmac_f32 v10, v64, v40
    v_fmac_f32 v11, v64, v41
    v_fmac_f32 v9, v64, v65
    v_fmac_f32 v10, v66, v42
    v_fmac_f32 v11, v66, v43
    v_fmac_f32 v9, v66, v67
    v_fmac_f32 v10, v68, v44
    v_fmac_f32 v11, v68, v45
    v_fmac_f32 v9, v68, v69
    v_fmac_f32 v10, v70, v46
    v_fmac_f32 v11, v70, v47
    v_fmac_f32 v9, v70, v71
    v_cmp_eq_u32 vcc, 0x300, v5
    s_nop 1
    v_cndmask_b32 v10, v10, v8, vcc
    v_cndmask_b32 v11, v11, v9, vcc
    v_min_u32 v10, -2, v10
    v_min_u32 v11, -2, v11
    v_cmp_ge_u32 vcc, 0x300, v5
    s_nop 0
    s_and_saveexec_b64 s[92:93], vcc
    buffer_store_dwordx2 v[10:11], v5, s[60:63], s10 offen sc1
    s_mov_b64 exec, -1
L_cmb3:
    s_cmp_ge_u32 s2, 160
    s_cbranch_scc1 L_final
    s_cmp_ge_u32 s3, 4
    s_cbranch_scc1 L_u1
    s_mul_i32 s9, s2, 205
    s_lshr_b32 s9, s9, 11
    s_lshl_b32 s9, s9, 1
    s_and_b32 s10, s3, 1
    s_add_u32 s9, s9, s10
    s_lshl_b32 s9, s9, 14
    s_lshr_b32 s10, s3, 1
    s_lshl_b32 s10, s10, 10
    s_add_u32 s9, s9, s10
    s_add_u32 s9, s9, 1114112
    v_lshlrev_b32 v5, 4, v1
    s_mov_b32 s94, 262144
    s_mov_b32 s95, 0xff
L_p1:
    s_bitcmp1_b32 s95, 0
    s_cbranch_scc0 L_p1s0
    s_add_u32 s10, s9, 0
    buffer_load_dwordx4 v[56:59], v5, s[60:63], s10 offen sc1
    buffer_load_dwordx2 v[88:89], off, s[60:63], s10 offset:768 sc1
L_p1s0:
    s_bitcmp1_b32 s95, 1
    s_cbranch_scc0 L_p1s1
    s_add_u32 s10, s9, 2048
    buffer_load_dwordx4 v[60:63], v5, s[60:63], s10 offen sc1
    buffer_load_dwordx2 v[90:91], off, s[60:63], s10 offset:768 sc1
L_p1s1:
    s_bitcmp1_b32 s95, 2
    s_cbranch_scc0 L_p1s2
    s_add_u32 s10, s9, 4096
    buffer_load_dwordx4 v[64:67], v5, s[60:63], s10 offen sc1
    buffer_load_dwordx2 v[92:93], off, s[60:63], s10 offset:768 sc1
L_p1s2:
    s_bitcmp1_b32 s95, 3
    s_cbranch_scc0 L_p1s3
    s_add_u32 s10, s9, 6144
    buffer_load_dwordx4 v[68:71], v5, s[60:63], s10 offen sc1
    buffer_load_dwordx2 v[94:95], off, s[60:63], s10 offset:768 sc1
L_p1s3:
    s_bitcmp1_b32 s95, 4
    s_cbranch_scc0 L_p1s4
    s_add_u32 s10, s9, 8192
    buffer_load_dwordx4 v[72:75], v5, s[60:63], s10 offen sc1
    buffer_load_dwordx2 v[96:97], off, s[60:63], s10 offset:768 sc1
L_p1s4:
    s_bitcmp1_b32 s95, 5
    s_cbranch_scc0 L_p1s5
    s_add_u32 s10, s9, 10240
    buffer_load_dwordx4 v[76:79], v5, s[60:63], s10 offen sc1
    buffer_load_dwordx2 v[98:99], off, s[60:63], s10 offset:768 sc1
L_p1s5:
    s_bitcmp1_b32 s95, 6
    s_cbranch_scc0 L_p1s6
    s_add_u32 s10, s9, 12288
    buffer_load_dwordx4 v[80:83], v5, s[60:63], s10 offen sc1
    buffer_load_dwordx2 v[100:101], off, s[60:63], s10 offset:768 sc1
L_p1s6:
    s_bitcmp1_b32 s95, 7
    s_cbranch_scc0 L_p1s7
    s_add_u32 s10, s9, 14336
    buffer_load_dwordx4 v[84:87], v5, s[60:63], s10 offen sc1
    buffer_load_dwordx2 v[102:103], off, s[60:63], s10 offset:768 sc1
L_p1s7:
    s_waitcnt vmcnt(0)
    v_max3_u32 v32, v56, v57, v58
    v_max3_u32 v33, v60, v61, v62
    v_max3_u32 v34, v64, v65, v66
    v_max3_u32 v35, v68, v69, v70
    v_max3_u32 v36, v72, v73, v74
    v_max3_u32 v37, v76, v77, v78
    v_max3_u32 v38, v80, v81, v82
    v_max3_u32 v39, v84, v85, v86
    s_mov_b32 exec_hi, 0xffff
    v_max3_u32 v32, v32, v59, v88
    v_max3_u32 v33, v33, v63, v90
    v_max3_u32 v34, v34, v67, v92
    v_max3_u32 v35, v35, v71, v94
    v_max3_u32 v36, v36, v75, v96
    v_max3_u32 v37, v37, v79, v98
    v_max3_u32 v38, v38, v83, v100
    v_max3_u32 v39, v39, v87, v102
    v_max_u32 v32, v32, v89
    v_max_u32 v33, v33, v91
    v_max_u32 v34, v34, v93
    v_max_u32 v35, v35, v95
    v_max_u32 v36, v36, v97
    v_max_u32 v37, v37, v99
    v_max_u32 v38, v38, v101
    v_max_u32 v39, v39, v103
    s_mov_b32 s11, 0
    v_cmp_eq_u32 vcc, -1, v32
    s_nop 0
    s_cmp_lg_u64 vcc, 0
    s_cselect_b32 s10, 1, 0
    s_or_b32 s11, s11, s10
    v_cmp_eq_u32 vcc, -1, v33
    s_nop 0
    s_cmp_lg_u64 vcc, 0
    s_cselect_b32 s10, 2, 0
    s_or_b32 s11, s11, s10
    v_cmp_eq_u32 vcc, -1, v34
    s_nop 0
    s_cmp_lg_u64 vcc, 0
    s_cselect_b32 s10, 4, 0
    s_or_b32 s11, s11, s10
    v_cmp_eq_u32 vcc, -1, v35
    s_nop 0
    s_cmp_lg_u64 vcc, 0
    s_cselect_b32 s10, 8, 0
    s_or_b32 s11, s11, s10
    v_cmp_eq_u32 vcc, -1, v36
    s_nop 0
    s_cmp_lg_u64 vcc, 0
    s_cselect_b32 s10, 16, 0
    s_or_b32 s11, s11, s10
    v_cmp_eq_u32 vcc, -1, v37
    s_nop 0
    s_cmp_lg_u64 vcc, 0
    s_cselect_b32 s10, 32, 0
    s_or_b32 s11, s11, s10
    v_cmp_eq_u32 vcc, -1, v38
    s_nop 0
    s_cmp_lg_u64 vcc, 0
    s_cselect_b32 s10, 64, 0
    s_or_b32 s11, s11, s10
    v_cmp_eq_u32 vcc, -1, v39
    s_nop 0
    s_cmp_lg_u64 vcc, 0
    s_cselect_b32 s10, 128, 0
    s_or_b32 s11, s11, s10
    s_mov_b64 exec, -1
    s_and_b32 s95, s95, s11
    s_cbranch_scc0 L_p1ok
    s_sub_u32 s94, s94, 1
    s_cmp_lg_u32 s94, 0
    s_cbranch_scc1 L_p1
L_p1ok:
    v_max3_f32 v8, v88, v90, v92
    v_max3_f32 v8, v8, v94, v96
    v_max3_f32 v8, v8, v98, v100
    v_max_f32 v8, v8, v102
    v_sub_f32 v88, v88, v8
    v_sub_f32 v90, v90, v8
    v_sub_f32 v92, v92, v8
    v_sub_f32 v94, v94, v8
    v_sub_f32 v96, v96, v8
    v_sub_f32 v98, v98, v8
    v_sub_f32 v100, v100, v8
    v_sub_f32 v102, v102, v8
    v_mul_f32 v88, 0x3fb8aa3b, v88
    v_mul_f32 v90, 0x3fb8aa3b, v90
    v_mul_f32 v92, 0x3fb8aa3b, v92
    v_mul_f32 v94, 0x3fb8aa3b, v94
    v_mul_f32 v96, 0x3fb8aa3b, v96
    v_mul_f32 v98, 0x3fb8aa3b, v98
    v_mul_f32 v100, 0x3fb8aa3b, v100
    v_mul_f32 v102, 0x3fb8aa3b, v102
    v_exp_f32 v88, v88
    v_exp_f32 v90, v90
    v_exp_f32 v92, v92
    v_exp_f32 v94, v94
    v_exp_f32 v96, v96
    v_exp_f32 v98, v98
    v_exp_f32 v100, v100
    v_exp_f32 v102, v102
    v_mul_f32 v9, v88, v89
    v_mul_f32 v32, v88, v56
    v_mul_f32 v33, v88, v57
    v_mul_f32 v34, v88, v58
    v_mul_f32 v35, v88, v59
    v_fmac_f32 v9, v90, v91
    v_fmac_f32 v32, v90, v60
    v_fmac_f32 v33, v90, v61
    v_fmac_f32 v34, v90, v62
    v_fmac_f32 v35, v90, v63
    v_fmac_f32 v9, v92, v93
    v_fmac_f32 v32, v92, v64
    v_fmac_f32 v33, v92, v65
    v_fmac_f32 v34, v92, v66
    v_fmac_f32 v35, v92, v67
    v_fmac_f32 v9, v94, v95
    v_fmac_f32 v32, v94, v68
    v_fmac_f32 v33, v94, v69
    v_fmac_f32 v34, v94, v70
    v_fmac_f32 v35, v94, v71
    v_fmac_f32 v9, v96, v97
    v_fmac_f32 v32, v96, v72
    v_fmac_f32 v33, v96, v73
    v_fmac_f32 v34, v96, v74
    v_fmac_f32 v35, v96, v75
    v_fmac_f32 v9, v98, v99
    v_fmac_f32 v32, v98, v76
    v_fmac_f32 v33, v98, v77
    v_fmac_f32 v34, v98, v78
    v_fmac_f32 v35, v98, v79
    v_fmac_f32 v9, v100, v101
    v_fmac_f32 v32, v100, v80
    v_fmac_f32 v33, v100, v81
    v_fmac_f32 v34, v100, v82
    v_fmac_f32 v35, v100, v83
    v_fmac_f32 v9, v102, v103
    v_fmac_f32 v32, v102, v84
    v_fmac_f32 v33, v102, v85
    v_fmac_f32 v34, v102, v86
    v_fmac_f32 v35, v102, v87
    v_rcp_f32 v10, v9
    s_mul_i32 s11, s3, 384
    v_lshlrev_b32 v11, 3, v1
    v_add_u32 v11, s11, v11
    v_mul_f32 v36, v32, v10
    v_mul_f32 v37, v33, v10
    v_mul_f32 v38, v34, v10
    v_mul_f32 v39, v35, v10
    v_fma_f32 v32, -v36, v9, v32
    v_fma_f32 v33, -v37, v9, v33
    v_fma_f32 v34, -v38, v9, v34
    v_fma_f32 v35, -v39, v9, v35
    v_fma_f32 v32, v32, v10, v36
    v_fma_f32 v33, v33, v10, v37
    v_fma_f32 v34, v34, v10, v38
    v_fma_f32 v35, v35, v10, v39
    v_cvt_pk_bf16_f32 v12, v32, v33
    v_cvt_pk_bf16_f32 v13, v34, v35
    s_mov_b32 exec_hi, 0xffff
    ds_write_b64 v11, v[12:13] offset:26112
    s_mov_b64 exec, -1
    s_waitcnt lgkmcnt(0)
    s_branch L_u2
L_u1:
    s_mul_i32 s9, s2, 205
    s_lshr_b32 s9, s9, 11
    s_mul_i32 s10, s9, 10
    s_sub_u32 s10, s2, s10
    s_mul_i32 s9, s9, 384
    s_sub_u32 s11, s3, 4
    s_mul_i32 s11, s11, 96
    s_add_u32 s9, s9, s11
    s_mul_i32 s9, s9, 1280
    s_lshl_b32 s10, s10, 7
    s_add_u32 s9, s9, s10
    v_and_b32 v5, 7, v1
    v_lshlrev_b32 v5, 4, v5
    v_lshrrev_b32 v6, 3, v1
    v_mul_u32_u24 v6, 2560, v6
    v_add_u32 v6, v6, v5
    s_add_u32 s10, s9, 0
    buffer_load_dwordx4 v[152:155], v6, s[64:67], s10 offen nt
    s_add_u32 s10, s9, 1280
    buffer_load_dwordx4 v[156:159], v6, s[64:67], s10 offen nt
    s_add_u32 s10, s9, 20480
    buffer_load_dwordx4 v[160:163], v6, s[64:67], s10 offen nt
    s_add_u32 s10, s9, 21760
    buffer_load_dwordx4 v[164:167], v6, s[64:67], s10 offen nt
    s_add_u32 s10, s9, 40960
    buffer_load_dwordx4 v[168:171], v6, s[64:67], s10 offen nt
    s_add_u32 s10, s9, 42240
    buffer_load_dwordx4 v[172:175], v6, s[64:67], s10 offen nt
    s_add_u32 s10, s9, 61440
    buffer_load_dwordx4 v[176:179], v6, s[64:67], s10 offen nt
    s_add_u32 s10, s9, 62720
    buffer_load_dwordx4 v[180:183], v6, s[64:67], s10 offen nt
    s_add_u32 s10, s9, 81920
    buffer_load_dwordx4 v[184:187], v6, s[64:67], s10 offen nt
    s_add_u32 s10, s9, 83200
    buffer_load_dwordx4 v[188:191], v6, s[64:67], s10 offen nt
    s_add_u32 s10, s9, 102400
    buffer_load_dwordx4 v[192:195], v6, s[64:67], s10 offen nt
    s_add_u32 s10, s9, 103680
    buffer_load_dwordx4 v[196:199], v6, s[64:67], s10 offen nt
    s_sub_u32 s9, s3, 4
    s_mul_i32 s11, s9, 192
    v_lshrrev_b32 v11, 3, v1
    v_lshlrev_b32 v11, 2, v11
    v_add_u32 v11, s11, v11
    s_lshl_b32 s11, s9, 9
    v_add_u32 v12, s11, v4
    v_mov_b32 v32, 0
    v_mov_b32 v33, 0
    v_mov_b32 v34, 0
    v_mov_b32 v35, 0
    v_mov_b32 v36, 0
    v_mov_b32 v37, 0
    v_mov_b32 v38, 0
    v_mov_b32 v39, 0
    v_mov_b32 v40, 0
    v_mov_b32 v41, 0
    v_mov_b32 v42, 0
    v_mov_b32 v43, 0
    v_mov_b32 v44, 0
    v_mov_b32 v45, 0
    v_mov_b32 v46, 0
    v_mov_b32 v47, 0
    s_waitcnt vmcnt(0)
    v_perm_b32 v104, v156, v152, s12
    v_perm_b32 v105, v156, v152, s13
    v_perm_b32 v106, v157, v153, s12
    v_perm_b32 v107, v157, v153, s13
    v_perm_b32 v108, v158, v154, s12
    v_perm_b32 v109, v158, v154, s13
    v_perm_b32 v110, v159, v155, s12
    v_perm_b32 v111, v159, v155, s13
    v_perm_b32 v112, v164, v160, s12
    v_perm_b32 v113, v164, v160, s13
    v_perm_b32 v114, v165, v161, s12
    v_perm_b32 v115, v165, v161, s13
    v_perm_b32 v116, v166, v162, s12
    v_perm_b32 v117, v166, v162, s13
    v_perm_b32 v118, v167, v163, s12
    v_perm_b32 v119, v167, v163, s13
    v_perm_b32 v120, v172, v168, s12
    v_perm_b32 v121, v172, v168, s13
    v_perm_b32 v122, v173, v169, s12
    v_perm_b32 v123, v173, v169, s13
    v_perm_b32 v124, v174, v170, s12
    v_perm_b32 v125, v174, v170, s13
    v_perm_b32 v126, v175, v171, s12
    v_perm_b32 v127, v175, v171, s13
    v_perm_b32 v128, v180, v176, s12
    v_perm_b32 v129, v180, v176, s13
    v_perm_b32 v130, v181, v177, s12
    v_perm_b32 v131, v181, v177, s13
    v_perm_b32 v132, v182, v178, s12
    v_perm_b32 v133, v182, v178, s13
    v_perm_b32 v134, v183, v179, s12
    v_perm_b32 v135, v183, v179, s13
    v_perm_b32 v136, v188, v184, s12
    v_perm_b32 v137, v188, v184, s13
    v_perm_b32 v138, v189, v185, s12
    v_perm_b32 v139, v189, v185, s13
    v_perm_b32 v140, v190, v186, s12
    v_perm_b32 v141, v190, v186, s13
    v_perm_b32 v142, v191, v187, s12
    v_perm_b32 v143, v191, v187, s13
    v_perm_b32 v144, v196, v192, s12
    v_perm_b32 v145, v196, v192, s13
    v_perm_b32 v146, v197, v193, s12
    v_perm_b32 v147, v197, v193, s13
    v_perm_b32 v148, v198, v194, s12
    v_perm_b32 v149, v198, v194, s13
    v_perm_b32 v150, v199, v195, s12
    v_perm_b32 v151, v199, v195, s13
L_u2:
    s_barrier
    s_cmp_lt_u32 s3, 4
    s_cbranch_scc1 L_u3
    ds_read_b32 v20, v11 offset:26112
    ds_read_b32 v21, v11 offset:26144
    ds_read_b32 v22, v11 offset:26176
    ds_read_b32 v23, v11 offset:26208
    ds_read_b32 v24, v11 offset:26240
    ds_read_b32 v25, v11 offset:26272
    ds_read_b32 v26, v11 offset:26880
    ds_read_b32 v27, v11 offset:26912
    ds_read_b32 v28, v11 offset:26944
    ds_read_b32 v29, v11 offset:26976
    ds_read_b32 v30, v11 offset:27008
    ds_read_b32 v31, v11 offset:27040
    s_waitcnt lgkmcnt(0)
    v_dot2c_f32_bf16 v32, v104, v20
    v_dot2c_f32_bf16 v40, v104, v26
    v_dot2c_f32_bf16 v33, v105, v20
    v_dot2c_f32_bf16 v41, v105, v26
    v_dot2c_f32_bf16 v34, v106, v20
    v_dot2c_f32_bf16 v42, v106, v26
    v_dot2c_f32_bf16 v35, v107, v20
    v_dot2c_f32_bf16 v43, v107, v26
    v_dot2c_f32_bf16 v36, v108, v20
    v_dot2c_f32_bf16 v44, v108, v26
    v_dot2c_f32_bf16 v37, v109, v20
    v_dot2c_f32_bf16 v45, v109, v26
    v_dot2c_f32_bf16 v38, v110, v20
    v_dot2c_f32_bf16 v46, v110, v26
    v_dot2c_f32_bf16 v39, v111, v20
    v_dot2c_f32_bf16 v47, v111, v26
    v_dot2c_f32_bf16 v32, v112, v21
    v_dot2c_f32_bf16 v40, v112, v27
    v_dot2c_f32_bf16 v33, v113, v21
    v_dot2c_f32_bf16 v41, v113, v27
    v_dot2c_f32_bf16 v34, v114, v21
    v_dot2c_f32_bf16 v42, v114, v27
    v_dot2c_f32_bf16 v35, v115, v21
    v_dot2c_f32_bf16 v43, v115, v27
    v_dot2c_f32_bf16 v36, v116, v21
    v_dot2c_f32_bf16 v44, v116, v27
    v_dot2c_f32_bf16 v37, v117, v21
    v_dot2c_f32_bf16 v45, v117, v27
    v_dot2c_f32_bf16 v38, v118, v21
    v_dot2c_f32_bf16 v46, v118, v27
    v_dot2c_f32_bf16 v39, v119, v21
    v_dot2c_f32_bf16 v47, v119, v27
    v_dot2c_f32_bf16 v32, v120, v22
    v_dot2c_f32_bf16 v40, v120, v28
    v_dot2c_f32_bf16 v33, v121, v22
    v_dot2c_f32_bf16 v41, v121, v28
    v_dot2c_f32_bf16 v34, v122, v22
    v_dot2c_f32_bf16 v42, v122, v28
    v_dot2c_f32_bf16 v35, v123, v22
    v_dot2c_f32_bf16 v43, v123, v28
    v_dot2c_f32_bf16 v36, v124, v22
    v_dot2c_f32_bf16 v44, v124, v28
    v_dot2c_f32_bf16 v37, v125, v22
    v_dot2c_f32_bf16 v45, v125, v28
    v_dot2c_f32_bf16 v38, v126, v22
    v_dot2c_f32_bf16 v46, v126, v28
    v_dot2c_f32_bf16 v39, v127, v22
    v_dot2c_f32_bf16 v47, v127, v28
    v_dot2c_f32_bf16 v32, v128, v23
    v_dot2c_f32_bf16 v40, v128, v29
    v_dot2c_f32_bf16 v33, v129, v23
    v_dot2c_f32_bf16 v41, v129, v29
    v_dot2c_f32_bf16 v34, v130, v23
    v_dot2c_f32_bf16 v42, v130, v29
    v_dot2c_f32_bf16 v35, v131, v23
    v_dot2c_f32_bf16 v43, v131, v29
    v_dot2c_f32_bf16 v36, v132, v23
    v_dot2c_f32_bf16 v44, v132, v29
    v_dot2c_f32_bf16 v37, v133, v23
    v_dot2c_f32_bf16 v45, v133, v29
    v_dot2c_f32_bf16 v38, v134, v23
    v_dot2c_f32_bf16 v46, v134, v29
    v_dot2c_f32_bf16 v39, v135, v23
    v_dot2c_f32_bf16 v47, v135, v29
    v_dot2c_f32_bf16 v32, v136, v24
    v_dot2c_f32_bf16 v40, v136, v30
    v_dot2c_f32_bf16 v33, v137, v24
    v_dot2c_f32_bf16 v41, v137, v30
    v_dot2c_f32_bf16 v34, v138, v24
    v_dot2c_f32_bf16 v42, v138, v30
    v_dot2c_f32_bf16 v35, v139, v24
    v_dot2c_f32_bf16 v43, v139, v30
    v_dot2c_f32_bf16 v36, v140, v24
    v_dot2c_f32_bf16 v44, v140, v30
    v_dot2c_f32_bf16 v37, v141, v24
    v_dot2c_f32_bf16 v45, v141, v30
    v_dot2c_f32_bf16 v38, v142, v24
    v_dot2c_f32_bf16 v46, v142, v30
    v_dot2c_f32_bf16 v39, v143, v24
    v_dot2c_f32_bf16 v47, v143, v30
    v_dot2c_f32_bf16 v32, v144, v25
    v_dot2c_f32_bf16 v40, v144, v31
    v_dot2c_f32_bf16 v33, v145, v25
    v_dot2c_f32_bf16 v41, v145, v31
    v_dot2c_f32_bf16 v34, v146, v25
    v_dot2c_f32_bf16 v42, v146, v31
    v_dot2c_f32_bf16 v35, v147, v25
    v_dot2c_f32_bf16 v43, v147, v31
    v_dot2c_f32_bf16 v36, v148, v25
    v_dot2c_f32_bf16 v44, v148, v31
    v_dot2c_f32_bf16 v37, v149, v25
    v_dot2c_f32_bf16 v45, v149, v31
    v_dot2c_f32_bf16 v38, v150, v25
    v_dot2c_f32_bf16 v46, v150, v31
    v_dot2c_f32_bf16 v39, v151, v25
    v_dot2c_f32_bf16 v47, v151, v31
    v_permlane32_swap_b32 v32, v36
    v_permlane32_swap_b32 v33, v37
    v_permlane32_swap_b32 v34, v38
    v_permlane32_swap_b32 v35, v39
    v_permlane32_swap_b32 v40, v44
    v_permlane32_swap_b32 v41, v45
    v_permlane32_swap_b32 v42, v46
    v_permlane32_swap_b32 v43, v47
    v_add_f32 v32, v32, v36
    v_add_f32 v33, v33, v37
    v_add_f32 v34, v34, v38
    v_add_f32 v35, v35, v39
    v_add_f32 v40, v40, v44
    v_add_f32 v41, v41, v45
    v_add_f32 v42, v42, v46
    v_add_f32 v43, v43, v47
    v_permlane16_swap_b32 v32, v34
    v_permlane16_swap_b32 v33, v35
    v_permlane16_swap_b32 v40, v42
    v_permlane16_swap_b32 v41, v43
    v_add_f32 v32, v32, v34
    v_add_f32 v33, v33, v35
    v_add_f32 v40, v40, v42
    v_add_f32 v41, v41, v43
    v_add_f32_dpp v5, v32, v32 row_ror:8 row_mask:0xf bank_mask:0x3
    s_nop 1
    v_add_f32_dpp v5, v33, v33 row_ror:8 row_mask:0xf bank_mask:0xc
    v_add_f32_dpp v6, v40, v40 row_ror:8 row_mask:0xf bank_mask:0x3
    s_nop 1
    v_add_f32_dpp v6, v41, v41 row_ror:8 row_mask:0xf bank_mask:0xc
    ds_write_b32 v12, v5 offset:27648
    ds_write_b32 v12, v6 offset:27904
    s_waitcnt lgkmcnt(0)
L_u3:
    s_nop 4
    v_lshlrev_b32 v5, 2, v0
    s_lshl_b32 s11, s2, 9
    s_add_u32 s11, s11, 983040
    s_lshl_b32 s10, s2, 2
    s_add_u32 s10, s10, 917504
    v_lshlrev_b32 v6, 12, v1
    v_mov_b32 v7, 1
    s_barrier
    s_cmp_ge_u32 s3, 2
    s_cbranch_scc1 L_final
    ds_read_b32 v32, v5 offset:27648
    ds_read_b32 v33, v5 offset:28160
    ds_read_b32 v34, v5 offset:28672
    ds_read_b32 v35, v5 offset:29184
    s_waitcnt lgkmcnt(0)
    v_add_f32 v32, v32, v33
    v_add_f32 v34, v34, v35
    v_add_f32 v32, v32, v34
    v_min_u32 v32, -2, v32
    buffer_store_dword v32, v5, s[60:63], s11 offen sc1
    s_cmp_lg_u32 s3, 1
    s_cbranch_scc1 L_final
    s_mov_b64 exec, 0xff
    buffer_store_dword v7, v6, s[60:63], s10 offen sc1
    s_mov_b64 exec, -1
L_final:
    s_nop 4
    s_lshr_b32 s4, s2, 7
    s_and_b32 s5, s2, 127
    s_mul_i32 s5, s5, 5
    v_lshlrev_b32 v232, 16, v232
    v_lshlrev_b32 v233, 16, v233
    v_lshlrev_b32 v234, 16, v234
    v_lshlrev_b32 v235, 16, v235
    v_lshlrev_b32 v236, 16, v236
    v_lshlrev_b32 v237, 16, v237
    v_lshlrev_b32 v238, 16, v238
    v_lshlrev_b32 v239, 16, v239
    v_lshlrev_b32 v240, 16, v240
    v_lshlrev_b32 v241, 16, v241
    v_lshlrev_b32 v208, 16, v242
    v_and_b32 v209, s14, v242
    v_lshlrev_b32 v210, 16, v243
    v_and_b32 v211, s14, v243
    v_lshlrev_b32 v6, 4, v1
    s_mov_b32 s94, 262144
    s_cmp_lt_u32 s2, 160
    s_cbranch_scc1 L_nogate
    s_cmp_lg_u32 s3, 2
    s_cbranch_scc1 L_gated
    s_and_b32 s10, s2, 7
    s_lshl_b32 s10, s10, 12
    s_add_u32 s10, s10, 917504
    s_mov_b32 exec_hi, 0xff
L_gate:
    buffer_load_dwordx4 v[104:107], v6, s[60:63], s10 offen sc1
    s_waitcnt vmcnt(0)
    v_max3_u32 v7, v104, v105, v106
    v_max_u32 v7, v7, v107
    v_cmp_eq_u32 vcc, -1, v7
    s_nop 0
    s_bcnt1_i32_b64 s11, vcc
    s_cmp_le_u32 s11, 32
    s_cbranch_scc1 L_gate_ok
    s_sleep 4
    s_sub_u32 s94, s94, 1
    s_cmp_lg_u32 s94, 0
    s_cbranch_scc1 L_gate
L_gate_ok:
    s_mov_b64 exec, -1
L_gated:
    s_barrier
L_nogate:
    v_lshlrev_b32 v5, 4, v0
    s_cmp_lt_u32 s3, 4
    s_cbranch_scc1 L_nogather
    s_sub_u32 s11, s3, 4
    s_mul_i32 s9, s11, 20480
    s_lshl_b32 s10, s4, 8
    s_add_u32 s9, s9, s10
    s_add_u32 s9, s9, 983040
    v_lshrrev_b32 v8, 4, v1
    v_and_b32 v7, 15, v1
    v_lshlrev_b32 v5, 9, v8
    v_lshl_add_u32 v5, v7, 4, v5
    s_mul_i32 s11, s11, 2560
    v_add_u32 v8, s11, v6
    s_mov_b64 s[44:45], -1
    s_mov_b64 s[46:47], -1
    s_mov_b32 s48, -1
    s_mov_b32 s49, 0
    s_mov_b64 s[50:51], -1
    s_mov_b64 s[52:53], -1
    s_mov_b32 s54, -1
    s_mov_b32 s55, 0
    s_mov_b64 s[56:57], -1
    s_mov_b64 s[58:59], -1
    s_mov_b32 s80, -1
    s_mov_b32 s81, 0
    s_mov_b64 s[82:83], -1
    s_mov_b64 s[84:85], -1
    s_mov_b32 s86, -1
    s_mov_b32 s87, 0
    s_mov_b32 s94, 262144
L_p2:
    s_mov_b64 exec, s[44:45]
    s_cbranch_execz L_p2s0
    s_add_u32 s10, s9, 0
    buffer_load_dwordx4 v[56:59], v5, s[60:63], s10 offen sc1
L_p2s0:
    s_mov_b64 exec, s[46:47]
    s_cbranch_execz L_p2s1
    s_add_u32 s10, s9, 2048
    buffer_load_dwordx4 v[60:63], v5, s[60:63], s10 offen sc1
L_p2s1:
    s_mov_b64 exec, s[48:49]
    s_cbranch_execz L_p2s2
    s_add_u32 s10, s9, 4096
    buffer_load_dwordx4 v[64:67], v5, s[60:63], s10 offen sc1
L_p2s2:
    s_mov_b64 exec, s[50:51]
    s_cbranch_execz L_p2s3
    s_add_u32 s10, s9, 5120
    buffer_load_dwordx4 v[68:71], v5, s[60:63], s10 offen sc1
L_p2s3:
    s_mov_b64 exec, s[52:53]
    s_cbranch_execz L_p2s4
    s_add_u32 s10, s9, 7168
    buffer_load_dwordx4 v[72:75], v5, s[60:63], s10 offen sc1
L_p2s4:
    s_mov_b64 exec, s[54:55]
    s_cbranch_execz L_p2s5
    s_add_u32 s10, s9, 9216
    buffer_load_dwordx4 v[76:79], v5, s[60:63], s10 offen sc1
L_p2s5:
    s_mov_b64 exec, s[56:57]
    s_cbranch_execz L_p2s6
    s_add_u32 s10, s9, 10240
    buffer_load_dwordx4 v[80:83], v5, s[60:63], s10 offen sc1
L_p2s6:
    s_mov_b64 exec, s[58:59]
    s_cbranch_execz L_p2s7
    s_add_u32 s10, s9, 12288
    buffer_load_dwordx4 v[84:87], v5, s[60:63], s10 offen sc1
L_p2s7:
    s_mov_b64 exec, s[80:81]
    s_cbranch_execz L_p2s8
    s_add_u32 s10, s9, 14336
    buffer_load_dwordx4 v[88:91], v5, s[60:63], s10 offen sc1
L_p2s8:
    s_mov_b64 exec, s[82:83]
    s_cbranch_execz L_p2s9
    s_add_u32 s10, s9, 15360
    buffer_load_dwordx4 v[92:95], v5, s[60:63], s10 offen sc1
L_p2s9:
    s_mov_b64 exec, s[84:85]
    s_cbranch_execz L_p2s10
    s_add_u32 s10, s9, 17408
    buffer_load_dwordx4 v[96:99], v5, s[60:63], s10 offen sc1
L_p2s10:
    s_mov_b64 exec, s[86:87]
    s_cbranch_execz L_p2s11
    s_add_u32 s10, s9, 19456
    buffer_load_dwordx4 v[100:103], v5, s[60:63], s10 offen sc1
L_p2s11:
    s_mov_b64 exec, -1
    s_waitcnt vmcnt(0)
    s_mov_b64 s[92:93], 0
    v_max3_u32 v32, v56, v57, v58
    v_max3_u32 v33, v60, v61, v62
    v_max3_u32 v34, v64, v65, v66
    v_max3_u32 v35, v68, v69, v70
    v_max3_u32 v36, v72, v73, v74
    v_max3_u32 v37, v76, v77, v78
    v_max3_u32 v38, v80, v81, v82
    v_max3_u32 v39, v84, v85, v86
    v_max3_u32 v40, v88, v89, v90
    v_max3_u32 v41, v92, v93, v94
    v_max3_u32 v42, v96, v97, v98
    v_max3_u32 v43, v100, v101, v102
    v_max_u32 v32, v32, v59
    v_max_u32 v33, v33, v63
    v_max_u32 v34, v34, v67
    v_max_u32 v35, v35, v71
    v_max_u32 v36, v36, v75
    v_max_u32 v37, v37, v79
    v_max_u32 v38, v38, v83
    v_max_u32 v39, v39, v87
    v_max_u32 v40, v40, v91
    v_max_u32 v41, v41, v95
    v_max_u32 v42, v42, v99
    v_max_u32 v43, v43, v103
    v_cmp_eq_u32 vcc, -1, v32
    s_nop 0
    s_and_b64 s[44:45], s[44:45], vcc
    s_or_b64 s[92:93], s[92:93], s[44:45]
    v_cmp_eq_u32 vcc, -1, v33
    s_nop 0
    s_and_b64 s[46:47], s[46:47], vcc
    s_or_b64 s[92:93], s[92:93], s[46:47]
    v_cmp_eq_u32 vcc, -1, v34
    s_nop 0
    s_and_b64 s[48:49], s[48:49], vcc
    s_or_b64 s[92:93], s[92:93], s[48:49]
    v_cmp_eq_u32 vcc, -1, v35
    s_nop 0
    s_and_b64 s[50:51], s[50:51], vcc
    s_or_b64 s[92:93], s[92:93], s[50:51]
    v_cmp_eq_u32 vcc, -1, v36
    s_nop 0
    s_and_b64 s[52:53], s[52:53], vcc
    s_or_b64 s[92:93], s[92:93], s[52:53]
    v_cmp_eq_u32 vcc, -1, v37
    s_nop 0
    s_and_b64 s[54:55], s[54:55], vcc
    s_or_b64 s[92:93], s[92:93], s[54:55]
    v_cmp_eq_u32 vcc, -1, v38
    s_nop 0
    s_and_b64 s[56:57], s[56:57], vcc
    s_or_b64 s[92:93], s[92:93], s[56:57]
    v_cmp_eq_u32 vcc, -1, v39
    s_nop 0
    s_and_b64 s[58:59], s[58:59], vcc
    s_or_b64 s[92:93], s[92:93], s[58:59]
    v_cmp_eq_u32 vcc, -1, v40
    s_nop 0
    s_and_b64 s[80:81], s[80:81], vcc
    s_or_b64 s[92:93], s[92:93], s[80:81]
    v_cmp_eq_u32 vcc, -1, v41
    s_nop 0
    s_and_b64 s[82:83], s[82:83], vcc
    s_or_b64 s[92:93], s[92:93], s[82:83]
    v_cmp_eq_u32 vcc, -1, v42
    s_nop 0
    s_and_b64 s[84:85], s[84:85], vcc
    s_or_b64 s[92:93], s[92:93], s[84:85]
    v_cmp_eq_u32 vcc, -1, v43
    s_nop 0
    s_and_b64 s[86:87], s[86:87], vcc
    s_or_b64 s[92:93], s[92:93], s[86:87]
    s_cmp_eq_u64 s[92:93], 0
    s_cbranch_scc1 L_p2ok
    s_sleep 1
    s_sub_u32 s94, s94, 1
    s_cmp_lg_u32 s94, 0
    s_cbranch_scc1 L_p2
L_p2ok:
    s_nop 4
    v_add_f32 v56, v56, v68
    v_add_f32 v80, v80, v92
    v_add_f32 v57, v57, v69
    v_add_f32 v81, v81, v93
    v_add_f32 v58, v58, v70
    v_add_f32 v82, v82, v94
    v_add_f32 v59, v59, v71
    v_add_f32 v83, v83, v95
    v_add_f32 v60, v60, v72
    v_add_f32 v84, v84, v96
    v_add_f32 v61, v61, v73
    v_add_f32 v85, v85, v97
    v_add_f32 v62, v62, v74
    v_add_f32 v86, v86, v98
    v_add_f32 v63, v63, v75
    v_add_f32 v87, v87, v99
    v_add_f32 v64, v64, v76
    v_add_f32 v88, v88, v100
    v_add_f32 v65, v65, v77
    v_add_f32 v89, v89, v101
    v_add_f32 v66, v66, v78
    v_add_f32 v90, v90, v102
    v_add_f32 v67, v67, v79
    v_add_f32 v91, v91, v103
    v_add_f32 v56, v56, v80
    v_add_f32 v57, v57, v81
    v_add_f32 v58, v58, v82
    v_add_f32 v59, v59, v83
    v_add_f32 v60, v60, v84
    v_add_f32 v61, v61, v85
    v_add_f32 v62, v62, v86
    v_add_f32 v63, v63, v87
    v_add_f32 v64, v64, v88
    v_add_f32 v65, v65, v89
    v_add_f32 v66, v66, v90
    v_add_f32 v67, v67, v91
    ds_write_b128 v8, v[56:59] offset:31744
    ds_write_b128 v8, v[60:63] offset:32768
    s_mov_b32 exec_hi, 0
    ds_write_b128 v8, v[64:67] offset:33792
    s_mov_b64 exec, -1
    s_waitcnt lgkmcnt(0)
L_nogather:
    s_barrier
    s_cmp_ge_u32 s3, 3
    s_cbranch_scc1 L_h1
    v_cmp_gt_u32 vcc, 0xa0, v0
    s_nop 0
    s_and_saveexec_b64 s[10:11], vcc
    ds_read_b128 v[56:59], v5 offset:31744
    ds_read_b128 v[60:63], v5 offset:34304
    ds_read_b128 v[64:67], v5 offset:36864
    ds_read_b128 v[68:71], v5 offset:39424
    s_waitcnt lgkmcnt(0)
    v_add_f32 v56, v56, v60
    v_add_f32 v57, v57, v61
    v_add_f32 v58, v58, v62
    v_add_f32 v59, v59, v63
    v_add_f32 v64, v64, v68
    v_add_f32 v65, v65, v69
    v_add_f32 v66, v66, v70
    v_add_f32 v67, v67, v71
    v_add_f32 v56, v56, v64
    v_add_f32 v57, v57, v65
    v_add_f32 v58, v58, v66
    v_add_f32 v59, v59, v67
    v_cvt_pk_bf16_f32 v12, v56, v57
    v_cvt_pk_bf16_f32 v13, v58, v59
    v_lshlrev_b32 v56, 16, v12
    v_and_b32 v57, s14, v12
    v_lshlrev_b32 v58, 16, v13
    v_and_b32 v59, s14, v13
    v_add_f32 v56, v56, v208
    v_add_f32 v57, v57, v209
    v_add_f32 v58, v58, v210
    v_add_f32 v59, v59, v211
    v_cvt_pk_bf16_f32 v12, v56, v57
    v_cvt_pk_bf16_f32 v13, v58, v59
    v_lshlrev_b32 v56, 16, v12
    v_and_b32 v57, s14, v12
    v_lshlrev_b32 v58, 16, v13
    v_and_b32 v59, s14, v13
    ds_write_b128 v5, v[56:59] offset:52224
    s_mov_b64 exec, s[10:11]
    s_waitcnt lgkmcnt(0)
L_h1:
    v_lshlrev_b32 v5, 3, v1
    s_lshl_b32 s9, s5, 2
    v_mov_b32 v6, s9
    v_mov_b32 v7, 0
    s_barrier
    s_cmp_lg_u32 s3, 0
    s_cbranch_scc1 L_ln1
    ds_read_b32 v42, v6 offset:52224
    ds_read_b32 v43, v6 offset:52228
    ds_read_b32 v44, v6 offset:52232
    ds_read_b32 v45, v6 offset:52236
    ds_read_b32 v46, v6 offset:52240
    ds_read_b64 v[32:33], v5 offset:52224
    ds_read_b64 v[34:35], v5 offset:52736
    ds_read_b64 v[36:37], v5 offset:53248
    ds_read_b64 v[38:39], v5 offset:53760
    ds_read_b64 v[40:41], v5 offset:54272
    s_waitcnt lgkmcnt(0)
    v_sub_f32 v104, v32, v42
    v_sub_f32 v105, v33, v42
    v_add_f32 v20, v104, v105
    v_mul_f32 v21, v104, v104
    v_fmac_f32 v21, v105, v105
    v_sub_f32 v104, v34, v42
    v_add_f32 v20, v20, v104
    v_fmac_f32 v21, v104, v104
    v_sub_f32 v105, v35, v42
    v_add_f32 v20, v20, v105
    v_fmac_f32 v21, v105, v105
    v_sub_f32 v104, v36, v42
    v_add_f32 v20, v20, v104
    v_fmac_f32 v21, v104, v104
    v_sub_f32 v105, v37, v42
    v_add_f32 v20, v20, v105
    v_fmac_f32 v21, v105, v105
    v_sub_f32 v104, v38, v42
    v_add_f32 v20, v20, v104
    v_fmac_f32 v21, v104, v104
    v_sub_f32 v105, v39, v42
    v_add_f32 v20, v20, v105
    v_fmac_f32 v21, v105, v105
    v_sub_f32 v104, v40, v42
    v_add_f32 v20, v20, v104
    v_fmac_f32 v21, v104, v104
    v_sub_f32 v105, v41, v42
    v_add_f32 v20, v20, v105
    v_fmac_f32 v21, v105, v105
    s_nop 0
    v_add_f32_dpp v20, v20, v20 quad_perm:[1,0,3,2] row_mask:0xf bank_mask:0xf
    v_add_f32_dpp v21, v21, v21 quad_perm:[1,0,3,2] row_mask:0xf bank_mask:0xf
    s_nop 0
    v_add_f32_dpp v20, v20, v20 quad_perm:[2,3,0,1] row_mask:0xf bank_mask:0xf
    v_add_f32_dpp v21, v21, v21 quad_perm:[2,3,0,1] row_mask:0xf bank_mask:0xf
    s_nop 0
    v_add_f32_dpp v20, v20, v20 row_half_mirror row_mask:0xf bank_mask:0xf
    v_add_f32_dpp v21, v21, v21 row_half_mirror row_mask:0xf bank_mask:0xf
    s_nop 0
    v_add_f32_dpp v20, v20, v20 row_mirror row_mask:0xf bank_mask:0xf
    v_add_f32_dpp v21, v21, v21 row_mirror row_mask:0xf bank_mask:0xf
    v_mov_b32 v106, v20
    v_mov_b32 v107, v21
    s_nop 0
    v_permlane16_swap_b32 v20, v106
    v_permlane16_swap_b32 v21, v107
    v_add_f32 v20, v20, v106
    v_add_f32 v21, v21, v107
    v_mov_b32 v106, v20
    v_mov_b32 v107, v21
    s_nop 0
    v_permlane32_swap_b32 v20, v106
    v_permlane32_swap_b32 v21, v107
    v_add_f32 v20, v20, v106
    v_add_f32 v21, v21, v107
    v_mul_f32 v20, 0x3acccccd, v20
    v_mul_f32 v21, 0x3acccccd, v21
    v_fma_f32 v21, -v20, v20, v21
    v_max_f32 v21, 0, v21
    v_add_f32 v20, v20, v42
    v_cvt_pk_bf16_f32 v104, v20, v21
    v_lshlrev_b32 v20, 16, v104
    v_and_b32 v21, s14, v104
    v_add_f32 v21, 0x3727c5ac, v21
    v_cvt_pk_bf16_f32 v104, v21, v21
    v_lshlrev_b32 v21, 16, v104
    v_sqrt_f32 v21, v21
    s_nop 0
    v_cvt_pk_bf16_f32 v104, v21, v21
    v_lshlrev_b32 v21, 16, v104
    v_rcp_f32 v22, v21
    v_mov_b32 v48, v42
    v_mov_b32 v49, v43
    v_mov_b32 v50, v44
    v_mov_b32 v51, v45
    v_mov_b32 v52, v46
    v_mov_b32 v53, v46
    v_sub_f32 v32, v32, v20
    v_sub_f32 v33, v33, v20
    v_sub_f32 v34, v34, v20
    v_sub_f32 v35, v35, v20
    v_sub_f32 v36, v36, v20
    v_sub_f32 v37, v37, v20
    v_sub_f32 v38, v38, v20
    v_sub_f32 v39, v39, v20
    v_sub_f32 v40, v40, v20
    v_sub_f32 v41, v41, v20
    v_sub_f32 v48, v48, v20
    v_sub_f32 v49, v49, v20
    v_sub_f32 v50, v50, v20
    v_sub_f32 v51, v51, v20
    v_sub_f32 v52, v52, v20
    v_sub_f32 v53, v53, v20
    v_cvt_pk_bf16_f32 v104, v32, v33
    v_cvt_pk_bf16_f32 v106, v34, v35
    v_cvt_pk_bf16_f32 v108, v36, v37
    v_cvt_pk_bf16_f32 v110, v38, v39
    v_cvt_pk_bf16_f32 v112, v40, v41
    v_cvt_pk_bf16_f32 v114, v48, v49
    v_cvt_pk_bf16_f32 v116, v50, v51
    v_cvt_pk_bf16_f32 v118, v52, v53
    v_lshlrev_b32 v32, 16, v104
    v_and_b32 v33, s14, v104
    v_lshlrev_b32 v34, 16, v106
    v_and_b32 v35, s14, v106
    v_lshlrev_b32 v36, 16, v108
    v_and_b32 v37, s14, v108
    v_lshlrev_b32 v38, 16, v110
    v_and_b32 v39, s14, v110
    v_lshlrev_b32 v40, 16, v112
    v_and_b32 v41, s14, v112
    v_lshlrev_b32 v48, 16, v114
    v_and_b32 v49, s14, v114
    v_lshlrev_b32 v50, 16, v116
    v_and_b32 v51, s14, v116
    v_lshlrev_b32 v52, 16, v118
    v_and_b32 v53, s14, v118
    v_mul_f32 v104, v32, v22
    v_mul_f32 v105, v33, v22
    v_mul_f32 v106, v34, v22
    v_mul_f32 v107, v35, v22
    v_mul_f32 v108, v36, v22
    v_mul_f32 v109, v37, v22
    v_mul_f32 v110, v38, v22
    v_mul_f32 v111, v39, v22
    v_mul_f32 v112, v40, v22
    v_mul_f32 v113, v41, v22
    v_mul_f32 v114, v48, v22
    v_mul_f32 v115, v49, v22
    v_mul_f32 v116, v50, v22
    v_mul_f32 v117, v51, v22
    v_mul_f32 v118, v52, v22
    v_mul_f32 v119, v53, v22
    v_fma_f32 v32, -v104, v21, v32
    v_fma_f32 v33, -v105, v21, v33
    v_fma_f32 v34, -v106, v21, v34
    v_fma_f32 v35, -v107, v21, v35
    v_fma_f32 v36, -v108, v21, v36
    v_fma_f32 v37, -v109, v21, v37
    v_fma_f32 v38, -v110, v21, v38
    v_fma_f32 v39, -v111, v21, v39
    v_fma_f32 v40, -v112, v21, v40
    v_fma_f32 v41, -v113, v21, v41
    v_fma_f32 v48, -v114, v21, v48
    v_fma_f32 v49, -v115, v21, v49
    v_fma_f32 v50, -v116, v21, v50
    v_fma_f32 v51, -v117, v21, v51
    v_fma_f32 v52, -v118, v21, v52
    v_fma_f32 v53, -v119, v21, v53
    v_fma_f32 v32, v32, v22, v104
    v_fma_f32 v33, v33, v22, v105
    v_fma_f32 v34, v34, v22, v106
    v_fma_f32 v35, v35, v22, v107
    v_fma_f32 v36, v36, v22, v108
    v_fma_f32 v37, v37, v22, v109
    v_fma_f32 v38, v38, v22, v110
    v_fma_f32 v39, v39, v22, v111
    v_fma_f32 v40, v40, v22, v112
    v_fma_f32 v41, v41, v22, v113
    v_fma_f32 v48, v48, v22, v114
    v_fma_f32 v49, v49, v22, v115
    v_fma_f32 v50, v50, v22, v116
    v_fma_f32 v51, v51, v22, v117
    v_fma_f32 v52, v52, v22, v118
    v_fma_f32 v53, v53, v22, v119
    v_cvt_pk_bf16_f32 v104, v32, v33
    v_cvt_pk_bf16_f32 v106, v34, v35
    v_cvt_pk_bf16_f32 v108, v36, v37
    v_cvt_pk_bf16_f32 v110, v38, v39
    v_cvt_pk_bf16_f32 v112, v40, v41
    v_cvt_pk_bf16_f32 v114, v48, v49
    v_cvt_pk_bf16_f32 v116, v50, v51
    v_cvt_pk_bf16_f32 v118, v52, v53
    v_lshlrev_b32 v32, 16, v104
    v_and_b32 v33, s14, v104
    v_lshlrev_b32 v34, 16, v106
    v_and_b32 v35, s14, v106
    v_lshlrev_b32 v36, 16, v108
    v_and_b32 v37, s14, v108
    v_lshlrev_b32 v38, 16, v110
    v_and_b32 v39, s14, v110
    v_lshlrev_b32 v40, 16, v112
    v_and_b32 v41, s14, v112
    v_lshlrev_b32 v48, 16, v114
    v_and_b32 v49, s14, v114
    v_lshlrev_b32 v50, 16, v116
    v_and_b32 v51, s14, v116
    v_lshlrev_b32 v52, 16, v118
    v_and_b32 v53, s14, v118
    v_sub_f32 v104, v32, v48
    v_sub_f32 v105, v33, v48
    v_add_f32 v23, v104, v105
    v_mul_f32 v24, v104, v104
    v_fmac_f32 v24, v105, v105
    v_sub_f32 v104, v34, v48
    v_add_f32 v23, v23, v104
    v_fmac_f32 v24, v104, v104
    v_sub_f32 v105, v35, v48
    v_add_f32 v23, v23, v105
    v_fmac_f32 v24, v105, v105
    v_sub_f32 v104, v36, v48
    v_add_f32 v23, v23, v104
    v_fmac_f32 v24, v104, v104
    v_sub_f32 v105, v37, v48
    v_add_f32 v23, v23, v105
    v_fmac_f32 v24, v105, v105
    v_sub_f32 v104, v38, v48
    v_add_f32 v23, v23, v104
    v_fmac_f32 v24, v104, v104
    v_sub_f32 v105, v39, v48
    v_add_f32 v23, v23, v105
    v_fmac_f32 v24, v105, v105
    v_sub_f32 v104, v40, v48
    v_add_f32 v23, v23, v104
    v_fmac_f32 v24, v104, v104
    v_sub_f32 v105, v41, v48
    v_add_f32 v23, v23, v105
    v_fmac_f32 v24, v105, v105
    s_nop 0
    v_add_f32_dpp v23, v23, v23 quad_perm:[1,0,3,2] row_mask:0xf bank_mask:0xf
    v_add_f32_dpp v24, v24, v24 quad_perm:[1,0,3,2] row_mask:0xf bank_mask:0xf
    s_nop 0
    v_add_f32_dpp v23, v23, v23 quad_perm:[2,3,0,1] row_mask:0xf bank_mask:0xf
    v_add_f32_dpp v24, v24, v24 quad_perm:[2,3,0,1] row_mask:0xf bank_mask:0xf
    s_nop 0
    v_add_f32_dpp v23, v23, v23 row_half_mirror row_mask:0xf bank_mask:0xf
    v_add_f32_dpp v24, v24, v24 row_half_mirror row_mask:0xf bank_mask:0xf
    s_nop 0
    v_add_f32_dpp v23, v23, v23 row_mirror row_mask:0xf bank_mask:0xf
    v_add_f32_dpp v24, v24, v24 row_mirror row_mask:0xf bank_mask:0xf
    v_mov_b32 v106, v23
    v_mov_b32 v107, v24
    s_nop 0
    v_permlane16_swap_b32 v23, v106
    v_permlane16_swap_b32 v24, v107
    v_add_f32 v23, v23, v106
    v_add_f32 v24, v24, v107
    v_mov_b32 v106, v23
    v_mov_b32 v107, v24
    s_nop 0
    v_permlane32_swap_b32 v23, v106
    v_permlane32_swap_b32 v24, v107
    v_add_f32 v23, v23, v106
    v_add_f32 v24, v24, v107
    v_mul_f32 v23, 0x3acccccd, v23
    v_mul_f32 v24, 0x3acccccd, v24
    v_fma_f32 v24, -v23, v23, v24
    v_max_f32 v24, 0, v24
    v_add_f32 v23, v23, v48
    v_cvt_pk_bf16_f32 v104, v23, v24
    v_lshlrev_b32 v23, 16, v104
    v_and_b32 v24, s14, v104
    v_add_f32 v24, 0x3727c5ac, v24
    v_cvt_pk_bf16_f32 v104, v24, v24
    v_lshlrev_b32 v24, 16, v104
    v_sqrt_f32 v24, v24
    s_nop 0
    v_cvt_pk_bf16_f32 v104, v24, v24
    v_lshlrev_b32 v24, 16, v104
    v_rcp_f32 v25, v24
    v_sub_f32 v48, v48, v23
    v_sub_f32 v49, v49, v23
    v_sub_f32 v50, v50, v23
    v_sub_f32 v51, v51, v23
    v_sub_f32 v52, v52, v23
    v_sub_f32 v53, v53, v23
    v_cvt_pk_bf16_f32 v104, v48, v49
    v_cvt_pk_bf16_f32 v106, v50, v51
    v_cvt_pk_bf16_f32 v108, v52, v53
    v_lshlrev_b32 v48, 16, v104
    v_and_b32 v49, s14, v104
    v_lshlrev_b32 v50, 16, v106
    v_and_b32 v51, s14, v106
    v_lshlrev_b32 v52, 16, v108
    v_and_b32 v53, s14, v108
    v_mul_f32 v104, v48, v25
    v_mul_f32 v105, v49, v25
    v_mul_f32 v106, v50, v25
    v_mul_f32 v107, v51, v25
    v_mul_f32 v108, v52, v25
    v_mul_f32 v109, v53, v25
    v_fma_f32 v48, -v104, v24, v48
    v_fma_f32 v49, -v105, v24, v49
    v_fma_f32 v50, -v106, v24, v50
    v_fma_f32 v51, -v107, v24, v51
    v_fma_f32 v52, -v108, v24, v52
    v_fma_f32 v53, -v109, v24, v53
    v_fma_f32 v48, v48, v25, v104
    v_fma_f32 v49, v49, v25, v105
    v_fma_f32 v50, v50, v25, v106
    v_fma_f32 v51, v51, v25, v107
    v_fma_f32 v52, v52, v25, v108
    v_fma_f32 v53, v53, v25, v109
    v_cvt_pk_bf16_f32 v104, v48, v49
    v_cvt_pk_bf16_f32 v106, v50, v51
    v_cvt_pk_bf16_f32 v108, v52, v53
    v_lshlrev_b32 v48, 16, v104
    v_and_b32 v49, s14, v104
    v_lshlrev_b32 v50, 16, v106
    v_and_b32 v51, s14, v106
    v_lshlrev_b32 v52, 16, v108
    v_and_b32 v53, s14, v108
    ds_write_b128 v7, v[48:51] offset:55424
    ds_write_b32 v7, v52 offset:55440
    s_waitcnt lgkmcnt(0)
L_ln1:
    s_mov_b32 s9, 0xbdd2d3e8
    v_mov_b32 v26, 0xc0135761
    s_barrier
    ds_read_b128 v[48:51], v7 offset:55424
    ds_read_b32 v52, v7 offset:55440
    s_waitcnt lgkmcnt(0)
    v_mul_f32 v56, v48, v232
    v_mul_f32 v57, v48, v233
    v_mul_f32 v58, v48, v234
    v_mul_f32 v59, v49, v232
    v_mul_f32 v60, v49, v233
    v_mul_f32 v61, v49, v234
    v_mul_f32 v62, v50, v232
    v_mul_f32 v63, v50, v233
    v_mul_f32 v64, v50, v234
    v_mul_f32 v65, v51, v232
    v_mul_f32 v66, v51, v233
    v_mul_f32 v67, v51, v234
    v_mul_f32 v68, v52, v232
    v_mul_f32 v69, v52, v233
    v_mul_f32 v70, v52, v234
    v_mul_f32 v71, v52, v234
    v_cvt_pk_bf16_f32 v72, v56, v57
    v_cvt_pk_bf16_f32 v73, v58, v59
    v_cvt_pk_bf16_f32 v74, v60, v61
    v_cvt_pk_bf16_f32 v75, v62, v63
    v_cvt_pk_bf16_f32 v76, v64, v65
    v_cvt_pk_bf16_f32 v77, v66, v67
    v_cvt_pk_bf16_f32 v78, v68, v69
    v_cvt_pk_bf16_f32 v79, v70, v71
    v_lshlrev_b32 v56, 16, v72
    v_and_b32 v57, s14, v72
    v_lshlrev_b32 v58, 16, v73
    v_and_b32 v59, s14, v73
    v_lshlrev_b32 v60, 16, v74
    v_and_b32 v61, s14, v74
    v_lshlrev_b32 v62, 16, v75
    v_and_b32 v63, s14, v75
    v_lshlrev_b32 v64, 16, v76
    v_and_b32 v65, s14, v76
    v_lshlrev_b32 v66, 16, v77
    v_and_b32 v67, s14, v77
    v_lshlrev_b32 v68, 16, v78
    v_and_b32 v69, s14, v78
    v_lshlrev_b32 v70, 16, v79
    v_and_b32 v71, s14, v79
    v_add_f32 v56, v56, v235
    v_add_f32 v57, v57, v236
    v_add_f32 v58, v58, v237
    v_add_f32 v59, v59, v235
    v_add_f32 v60, v60, v236
    v_add_f32 v61, v61, v237
    v_add_f32 v62, v62, v235
    v_add_f32 v63, v63, v236
    v_add_f32 v64, v64, v237
    v_add_f32 v65, v65, v235
    v_add_f32 v66, v66, v236
    v_add_f32 v67, v67, v237
    v_add_f32 v68, v68, v235
    v_add_f32 v69, v69, v236
    v_add_f32 v70, v70, v237
    v_add_f32 v71, v71, v237
    v_cvt_pk_bf16_f32 v72, v56, v57
    v_cvt_pk_bf16_f32 v73, v58, v59
    v_cvt_pk_bf16_f32 v74, v60, v61
    v_cvt_pk_bf16_f32 v75, v62, v63
    v_cvt_pk_bf16_f32 v76, v64, v65
    v_cvt_pk_bf16_f32 v77, v66, v67
    v_cvt_pk_bf16_f32 v78, v68, v69
    v_cvt_pk_bf16_f32 v79, v70, v71
    v_lshlrev_b32 v56, 16, v72
    v_and_b32 v57, s14, v72
    v_lshlrev_b32 v58, 16, v73
    v_and_b32 v59, s14, v73
    v_lshlrev_b32 v60, 16, v74
    v_and_b32 v61, s14, v74
    v_lshlrev_b32 v62, 16, v75
    v_and_b32 v63, s14, v75
    v_lshlrev_b32 v64, 16, v76
    v_and_b32 v65, s14, v76
    v_lshlrev_b32 v66, 16, v77
    v_and_b32 v67, s14, v77
    v_lshlrev_b32 v68, 16, v78
    v_and_b32 v69, s14, v78
    v_lshlrev_b32 v70, 16, v79
    v_and_b32 v71, s14, v79
    v_mul_f32 v72, v56, v56
    v_mul_f32 v73, v57, v57
    v_mul_f32 v74, v58, v58
    v_mul_f32 v75, v59, v59
    v_mul_f32 v76, v60, v60
    v_mul_f32 v77, v61, v61
    v_mul_f32 v78, v62, v62
    v_mul_f32 v79, v63, v63
    v_mul_f32 v80, v64, v64
    v_mul_f32 v81, v65, v65
    v_mul_f32 v82, v66, v66
    v_mul_f32 v83, v67, v67
    v_mul_f32 v84, v68, v68
    v_mul_f32 v85, v69, v69
    v_mul_f32 v86, v70, v70
    v_fma_f32 v72, v72, s9, v26
    v_fma_f32 v73, v73, s9, v26
    v_fma_f32 v74, v74, s9, v26
    v_fma_f32 v75, v75, s9, v26
    v_fma_f32 v76, v76, s9, v26
    v_fma_f32 v77, v77, s9, v26
    v_fma_f32 v78, v78, s9, v26
    v_fma_f32 v79, v79, s9, v26
    v_fma_f32 v80, v80, s9, v26
    v_fma_f32 v81, v81, s9, v26
    v_fma_f32 v82, v82, s9, v26
    v_fma_f32 v83, v83, s9, v26
    v_fma_f32 v84, v84, s9, v26
    v_fma_f32 v85, v85, s9, v26
    v_fma_f32 v86, v86, s9, v26
    v_mul_f32 v72, v72, v56
    v_mul_f32 v73, v73, v57
    v_mul_f32 v74, v74, v58
    v_mul_f32 v75, v75, v59
    v_mul_f32 v76, v76, v60
    v_mul_f32 v77, v77, v61
    v_mul_f32 v78, v78, v62
    v_mul_f32 v79, v79, v63
    v_mul_f32 v80, v80, v64
    v_mul_f32 v81, v81, v65
    v_mul_f32 v82, v82, v66
    v_mul_f32 v83, v83, v67
    v_mul_f32 v84, v84, v68
    v_mul_f32 v85, v85, v69
    v_mul_f32 v86, v86, v70
    v_exp_f32 v72, v72
    v_exp_f32 v73, v73
    v_exp_f32 v74, v74
    v_exp_f32 v75, v75
    v_exp_f32 v76, v76
    v_exp_f32 v77, v77
    v_exp_f32 v78, v78
    v_exp_f32 v79, v79
    v_exp_f32 v80, v80
    v_exp_f32 v81, v81
    v_exp_f32 v82, v82
    v_exp_f32 v83, v83
    v_exp_f32 v84, v84
    v_exp_f32 v85, v85
    v_exp_f32 v86, v86
    v_add_f32 v72, 1.0, v72
    v_add_f32 v73, 1.0, v73
    v_add_f32 v74, 1.0, v74
    v_add_f32 v75, 1.0, v75
    v_add_f32 v76, 1.0, v76
    v_add_f32 v77, 1.0, v77
    v_add_f32 v78, 1.0, v78
    v_add_f32 v79, 1.0, v79
    v_add_f32 v80, 1.0, v80
    v_add_f32 v81, 1.0, v81
    v_add_f32 v82, 1.0, v82
    v_add_f32 v83, 1.0, v83
    v_add_f32 v84, 1.0, v84
    v_add_f32 v85, 1.0, v85
    v_add_f32 v86, 1.0, v86
    v_rcp_f32 v72, v72
    v_rcp_f32 v73, v73
    v_rcp_f32 v74, v74
    v_rcp_f32 v75, v75
    v_rcp_f32 v76, v76
    v_rcp_f32 v77, v77
    v_rcp_f32 v78, v78
    v_rcp_f32 v79, v79
    v_rcp_f32 v80, v80
    v_rcp_f32 v81, v81
    v_rcp_f32 v82, v82
    v_rcp_f32 v83, v83
    v_rcp_f32 v84, v84
    v_rcp_f32 v85, v85
    v_rcp_f32 v86, v86
    v_mul_f32 v56, v56, v72
    v_mul_f32 v57, v57, v73
    v_mul_f32 v58, v58, v74
    v_mul_f32 v59, v59, v75
    v_mul_f32 v60, v60, v76
    v_mul_f32 v61, v61, v77
    v_mul_f32 v62, v62, v78
    v_mul_f32 v63, v63, v79
    v_mul_f32 v64, v64, v80
    v_mul_f32 v65, v65, v81
    v_mul_f32 v66, v66, v82
    v_mul_f32 v67, v67, v83
    v_mul_f32 v68, v68, v84
    v_mul_f32 v69, v69, v85
    v_mul_f32 v70, v70, v86
    v_cvt_pk_bf16_f32 v72, v56, v57
    v_cvt_pk_bf16_f32 v73, v58, v59
    v_cvt_pk_bf16_f32 v74, v60, v61
    v_cvt_pk_bf16_f32 v75, v62, v63
    v_cvt_pk_bf16_f32 v76, v64, v65
    v_cvt_pk_bf16_f32 v77, v66, v67
    v_cvt_pk_bf16_f32 v78, v68, v69
    v_cvt_pk_bf16_f32 v79, v70, v71
    v_lshlrev_b32 v56, 16, v72
    v_and_b32 v57, s14, v72
    v_lshlrev_b32 v58, 16, v73
    v_and_b32 v59, s14, v73
    v_lshlrev_b32 v60, 16, v74
    v_and_b32 v61, s14, v74
    v_lshlrev_b32 v62, 16, v75
    v_and_b32 v63, s14, v75
    v_lshlrev_b32 v64, 16, v76
    v_and_b32 v65, s14, v76
    v_lshlrev_b32 v66, 16, v77
    v_and_b32 v67, s14, v77
    v_lshlrev_b32 v68, 16, v78
    v_and_b32 v69, s14, v78
    v_lshlrev_b32 v70, 16, v79
    v_and_b32 v71, s14, v79
    v_mul_f32 v27, v56, v238
    v_mul_f32 v28, v59, v238
    v_mul_f32 v29, v62, v238
    v_mul_f32 v30, v65, v238
    v_mul_f32 v31, v68, v238
    v_fmac_f32 v27, v57, v239
    v_fmac_f32 v28, v60, v239
    v_fmac_f32 v29, v63, v239
    v_fmac_f32 v30, v66, v239
    v_fmac_f32 v31, v69, v239
    v_fmac_f32 v27, v58, v240
    v_fmac_f32 v28, v61, v240
    v_fmac_f32 v29, v64, v240
    v_fmac_f32 v30, v67, v240
    v_fmac_f32 v31, v70, v240
    v_add_f32_dpp v27, v27, v27 quad_perm:[1,0,3,2] row_mask:0xf bank_mask:0xf
    v_add_f32_dpp v28, v28, v28 quad_perm:[1,0,3,2] row_mask:0xf bank_mask:0xf
    v_add_f32_dpp v29, v29, v29 quad_perm:[1,0,3,2] row_mask:0xf bank_mask:0xf
    v_add_f32_dpp v30, v30, v30 quad_perm:[1,0,3,2] row_mask:0xf bank_mask:0xf
    v_add_f32_dpp v31, v31, v31 quad_perm:[1,0,3,2] row_mask:0xf bank_mask:0xf
    v_add_f32_dpp v27, v27, v27 quad_perm:[2,3,0,1] row_mask:0xf bank_mask:0xf
    v_add_f32_dpp v28, v28, v28 quad_perm:[2,3,0,1] row_mask:0xf bank_mask:0xf
    v_add_f32_dpp v29, v29, v29 quad_perm:[2,3,0,1] row_mask:0xf bank_mask:0xf
    v_add_f32_dpp v30, v30, v30 quad_perm:[2,3,0,1] row_mask:0xf bank_mask:0xf
    v_add_f32_dpp v31, v31, v31 quad_perm:[2,3,0,1] row_mask:0xf bank_mask:0xf
    v_add_f32_dpp v27, v27, v27 row_half_mirror row_mask:0xf bank_mask:0xf
    v_add_f32_dpp v28, v28, v28 row_half_mirror row_mask:0xf bank_mask:0xf
    v_add_f32_dpp v29, v29, v29 row_half_mirror row_mask:0xf bank_mask:0xf
    v_add_f32_dpp v30, v30, v30 row_half_mirror row_mask:0xf bank_mask:0xf
    v_add_f32_dpp v31, v31, v31 row_half_mirror row_mask:0xf bank_mask:0xf
    v_add_f32_dpp v27, v27, v27 row_mirror row_mask:0xf bank_mask:0xf
    v_add_f32_dpp v28, v28, v28 row_mirror row_mask:0xf bank_mask:0xf
    v_add_f32_dpp v29, v29, v29 row_mirror row_mask:0xf bank_mask:0xf
    v_add_f32_dpp v30, v30, v30 row_mirror row_mask:0xf bank_mask:0xf
    v_add_f32_dpp v31, v31, v31 row_mirror row_mask:0xf bank_mask:0xf
    v_and_b32 v7, 15, v1
    v_cmp_eq_u32 vcc, 1, v7
    s_nop 1
    v_cndmask_b32 v27, v27, v28, vcc
    v_cndmask_b32 v42, v42, v43, vcc
    v_cmp_eq_u32 vcc, 2, v7
    s_nop 1
    v_cndmask_b32 v27, v27, v29, vcc
    v_cndmask_b32 v42, v42, v44, vcc
    v_cmp_eq_u32 vcc, 3, v7
    s_nop 1
    v_cndmask_b32 v27, v27, v30, vcc
    v_cndmask_b32 v42, v42, v45, vcc
    v_cmp_eq_u32 vcc, 4, v7
    s_nop 1
    v_cndmask_b32 v27, v27, v31, vcc
    v_cndmask_b32 v42, v42, v46, vcc
    v_lshrrev_b32 v6, 4, v1
    v_lshlrev_b32 v6, 2, v6
    v_lshl_add_u32 v6, v7, 7, v6
    s_lshl_b32 s9, s3, 4
    v_add_u32 v6, s9, v6
    v_cmp_gt_u32 vcc, 5, v7
    s_nop 0
    s_and_saveexec_b64 s[10:11], vcc
    ds_write_b32 v6, v27 offset:54784
    s_mov_b64 exec, -1
    v_lshlrev_b32 v5, 7, v1
    s_mov_b32 s72, s36
    s_mov_b32 s73, s37
    s_mov_b32 s74, 0xa00
    s_mov_b32 s75, 0x20000
    s_mul_i32 s9, s4, 640
    s_add_u32 s9, s9, s5
    s_lshl_b32 s15, s9, 1
    s_waitcnt lgkmcnt(0)
    s_barrier
    s_cmp_lg_u32 s3, 7
    s_cbranch_scc1 L_noep
    s_and_b32 s9, s2, 7
    s_cmp_lg_u32 s9, 0
    s_cbranch_scc1 L_done
    s_mov_b64 exec, 1
    buffer_store_dword v205, off, s[60:63], s79 offset:256 sc1
    s_branch L_done
L_noep:
    s_cmp_ge_u32 s3, 1
    s_cbranch_scc1 L_done
    s_mov_b64 exec, 31
    ds_read_b128 v[56:59], v5 offset:54784
    ds_read_b128 v[60:63], v5 offset:54800
    ds_read_b128 v[64:67], v5 offset:54816
    ds_read_b128 v[68:71], v5 offset:54832
    ds_read_b128 v[72:75], v5 offset:54848
    ds_read_b128 v[76:79], v5 offset:54864
    ds_read_b128 v[80:83], v5 offset:54880
    ds_read_b128 v[84:87], v5 offset:54896
    v_lshlrev_b32 v5, 1, v1
    s_waitcnt lgkmcnt(0)
    v_add_f32 v56, v56, v57
    v_add_f32 v58, v58, v59
    v_add_f32 v60, v60, v61
    v_add_f32 v62, v62, v63
    v_add_f32 v64, v64, v65
    v_add_f32 v66, v66, v67
    v_add_f32 v68, v68, v69
    v_add_f32 v70, v70, v71
    v_add_f32 v72, v72, v73
    v_add_f32 v74, v74, v75
    v_add_f32 v76, v76, v77
    v_add_f32 v78, v78, v79
    v_add_f32 v80, v80, v81
    v_add_f32 v82, v82, v83
    v_add_f32 v84, v84, v85
    v_add_f32 v86, v86, v87
    v_add_f32 v56, v56, v58
    v_add_f32 v60, v60, v62
    v_add_f32 v64, v64, v66
    v_add_f32 v68, v68, v70
    v_add_f32 v72, v72, v74
    v_add_f32 v76, v76, v78
    v_add_f32 v80, v80, v82
    v_add_f32 v84, v84, v86
    v_add_f32 v56, v56, v60
    v_add_f32 v64, v64, v68
    v_add_f32 v72, v72, v76
    v_add_f32 v80, v80, v84
    v_add_f32 v56, v56, v64
    v_add_f32 v72, v72, v80
    v_add_f32 v56, v56, v72
    v_cvt_pk_bf16_f32 v6, v56, v56
    v_lshlrev_b32 v56, 16, v6
    v_add_f32 v56, v56, v241
    v_cvt_pk_bf16_f32 v6, v56, v56
    v_lshlrev_b32 v56, 16, v6
    v_add_f32 v56, v56, v42
    v_cvt_pk_bf16_f32 v56, v56, v56
    buffer_store_short v56, v5, s[72:75], s15 offen
L_done:
    s_endpgm
.section .rodata,"a"
.p2align 6
.amdhsa_kernel sequential_preLN__gqa_block_cached__mixer_token_mlp__decode_kernel
  .amdhsa_next_free_vgpr 244
  .amdhsa_next_free_sgpr 102
  .amdhsa_accum_offset 244
  .amdhsa_group_segment_fixed_size 0
  .amdhsa_kernarg_size 104
  .amdhsa_user_sgpr_count 2
  .amdhsa_user_sgpr_kernarg_segment_ptr 1
  .amdhsa_system_sgpr_workgroup_id_x 1
  .amdhsa_float_denorm_mode_32 3
.end_amdhsa_kernel
```
